```python
import torch

def _softmax(x, axis=-1):
    return torch.softmax(x, dim=axis)

def _gelu(x):
    return torch.nn.functional.gelu(x, approximate='tanh')

def _silu(x):
    return torch.nn.functional.silu(x)

def _sigmoid(x):
    return torch.sigmoid(x)

def _layernorm(x, axis=-1, eps=1e-05):
    m = x.mean(dim=axis, keepdim=True)
    v = x.var(dim=axis, keepdim=True, unbiased=False)
    return (x - m) / torch.sqrt(v + eps)

def _scatter_add(tgt, idx, src, axis=0):
    return tgt.clone().index_add_(axis, idx, src)

def _segment_sum(src, seg, n):
    out = torch.zeros((n,) + src.shape[1:], dtype=src.dtype)
    return out.index_add_(0, seg, src)

def _pad(x, pw):
    flat = tuple((v for pair in reversed(pw) for v in pair))
    return torch.nn.functional.pad(x, flat)
kernel_name = 'adaLN_cond__sliding_block_cached__glu_gated_reglu__decode'

def setup_inputs():

    _w = lambda a: (lambda t: t.to(torch.bfloat16) if t.is_floating_point() else t)(torch.as_tensor(a))

    def _A_setup():
        B, Sq, D = (4, 1, 512)
        Hq, Hkv, Sk, Dh = (32, 8, 4096, 128)
        assert Hq % Hkv == 0, (Hq, Hkv)
        return {'x': _w((lambda *s: torch.randn(*s, dtype=torch.bfloat16) * 0.1)(B, Sq, D)), 'k_cache': _w((lambda *s: torch.randn(*s, dtype=torch.bfloat16) * 0.8)(B, Hkv, Sk, Dh)), 'v_cache': _w((lambda *s: torch.randn(*s, dtype=torch.bfloat16) * 3.2)(B, Hkv, Sk, Dh)), 'wq': _w((lambda *s: torch.randn(*s, dtype=torch.bfloat16) * 0.8)(D, Hq * Dh) * D ** (-0.5)), 'wo': _w((lambda *s: torch.randn(*s, dtype=torch.bfloat16) * 3.2)(Hq * Dh, D) * (Hq * Dh) ** (-0.5))}
    _A_in = _A_setup()

    def _B_setup():
        B, S, D, F = (4, 1, 512, 1792)
        return {'x': _w((lambda *s: torch.randn(*s, dtype=torch.bfloat16) * 0.1)(B, S, D)), 'W_gate': _w((lambda *s: torch.randn(*s, dtype=torch.bfloat16) * 3.2)(D, F) * (2.0 / D) ** 0.5), 'W_up': _w((lambda *s: torch.randn(*s, dtype=torch.bfloat16) * 3.2)(D, F) * (2.0 / D) ** 0.5), 'W_down': _w((lambda *s: torch.randn(*s, dtype=torch.bfloat16) * 3.2)(F, D) * (1.0 / F) ** 0.5)}
    _B_in = _B_setup()
    return {'A_x': _A_in['x'], 'A_k_cache': _A_in['k_cache'], 'A_v_cache': _A_in['v_cache'], 'A_wq': _A_in['wq'], 'A_wo': _A_in['wo'], 'B_x': _B_in['x'], 'B_W_gate': _B_in['W_gate'], 'B_W_up': _B_in['W_up'], 'B_W_down': _B_in['W_down'], 'c': _w((lambda *s: torch.randn(*s, dtype=torch.bfloat16) * 0.8)(4, 512) * 8.0), 'w_mod': _w((lambda *s: torch.randn(*s, dtype=torch.bfloat16) * 0.8)(512, 6 * 512) * 512 ** (-0.5) * 8.0)}

def reference(A_x, A_k_cache, A_v_cache, A_wq, A_wo, B_x, B_W_gate, B_W_up, B_W_down, c, w_mod):

    def _A_ref(x, k_cache, v_cache, wq, wo):
        B, Sq, D = x.shape
        Hq, Dh = (32, 128)
        Hkv, Sk = (k_cache.shape[1], k_cache.shape[2])
        W = min(4096, max(256, Sk // 4))
        rep = Hq // Hkv
        q = (lambda x, *d: x.permute(*d))((x @ wq).reshape(B, Sq, Hq, Dh), 0, 2, 1, 3)
        k = (lambda x, n, axis: torch.repeat_interleave(x, n, dim=axis))(k_cache[:, :, Sk - W:, :], rep, axis=1)
        v = (lambda x, n, axis: torch.repeat_interleave(x, n, dim=axis))(v_cache[:, :, Sk - W:, :], rep, axis=1)
        scores = torch.einsum('bhqd,bhkd->bhqk', q, k) * Dh ** (-0.5)
        p = _softmax(scores, axis=-1)
        o = torch.einsum('bhqk,bhkd->bhqd', p, v)
        return (lambda x, *d: x.permute(*d))(o, 0, 2, 1, 3).reshape(B, Sq, Hq * Dh) @ wo

    def _B_ref(x, W_gate, W_up, W_down):
        gate = torch.einsum('bsd,df->bsf', x, W_gate)
        up = torch.einsum('bsd,df->bsf', x, W_up)
        gate = gate * (lambda x, dt: x.to(dt))(gate > 0, gate.dtype)
        h = gate * up
        return torch.einsum('bsf,fd->bsd', h, W_down)
    x = A_x
    mod = (_silu(c) @ w_mod).reshape(c.shape[0], 6, 1, -1)
    sa, ca, ga, sb, cb, gb = (mod[:, 0].clone(), mod[:, 1].clone(), mod[:, 2].clone(), mod[:, 3].clone(), mod[:, 4].clone(), mod[:, 5].clone())
    h = _layernorm(x, axis=-1) * (1 + ca) + sa
    x = x + ga * _A_ref(h, A_k_cache, A_v_cache, A_wq, A_wo)
    h = _layernorm(x, axis=-1) * (1 + cb) + sb
    x = x + gb * _B_ref(h, B_W_gate, B_W_up, B_W_down)
    return x
```

```asm
; @launch grid=(256,1,1) block=(512,1,1) lds=140288
.amdgcn_target "amdgcn-amd-amdhsa--gfx950"
.text
.globl adaLN_cond__sliding_block_cached__glu_gated_reglu__decode_kernel
.p2align 8
.type adaLN_cond__sliding_block_cached__glu_gated_reglu__decode_kernel,@function
adaLN_cond__sliding_block_cached__glu_gated_reglu__decode_kernel:
L_START:
    s_cmp_ge_u32 s2, 256
    s_cbranch_scc1 L_END
    s_load_dwordx16 s[4:19], s[0:1], 0
    s_load_dwordx8 s[20:27], s[0:1], 64
    s_load_dwordx4 s[28:31], s[0:1], 96
    v_lshrrev_b32 v1, 6, v0
    v_and_b32 v0, 63, v0
    s_and_b32 s32, s2, 7
    s_lshr_b32 s33, s2, 3
    v_readfirstlane_b32 s34, v1
    s_nop 0
    s_cmp_eq_u32 s34, 7
    s_cbranch_scc0 Lpf_1
    s_getpc_b64 s[86:87]
Lpc_2:
    s_lshl_b32 s88, s33, 10
    s_sub_u32 s86, s86, Lpc_2-L_START
    s_subb_u32 s87, s87, 0
    v_lshl_add_u32 v204, v0, 4, s88
    v_min_u32 v204, (L_END-L_START-16)&0xfffffff0, v204
    v_mov_b32 v207, s87
    v_add_co_u32 v206, vcc, s86, v204
    s_nop 1
    v_addc_co_u32 v207, vcc, 0, v207, vcc
    global_load_dwordx4 v[200:203], v[206:207], off
Lpf_1:
    s_cmp_ge_u32 s33, 24
    s_cbranch_scc1 L_ENT_V
    s_cmp_ge_u32 s33, 16
    s_cbranch_scc1 L_ENT_K
    s_cmp_ge_u32 s33, 8
    s_cbranch_scc1 L_ENT_W
L_ENT_M:
    v_lshrrev_b32 v1, 4, v0
    v_and_b32 v3, 15, v0
    v_lshlrev_b32 v2, 1, v1
    v_xor_b32 v2, v2, v3
    v_and_b32 v4, 7, v2
    v_lshlrev_b32 v4, 4, v4
    v_lshrrev_b32 v2, 3, v2
    v_lshl_add_u32 v4, v2, 10, v4
    v_xor_b32 v5, 1024, v4
    v_mul_u32_u24 v1, 6144, v1
    v_add_u32 v32, v1, v4
    v_add_u32 v33, v1, v5
    s_lshl_b32 s59, s33, 6
    s_lshl_b32 s61, s34, 3
    s_add_u32 s59, s59, s61
    s_mul_i32 s59, s59, 6144
    s_lshl_b32 s61, s32, 7
    s_add_u32 s59, s59, s61
    s_lshl_b32 s61, s34, 11
    s_mov_b32 m0, s61
    s_and_b32 s62, s34, 3
    s_lshl_b32 s62, s62, 10
    v_lshlrev_b32 v6, 4, v0
    v_lshlrev_b32 v7, 1, v0
    s_lshl_b32 s63, s33, 7
    s_add_u32 s63, s63, s62
    s_waitcnt lgkmcnt(0)
    s_load_dword s36, s[30:31], 0
    s_mov_b32 s44, s24
    s_mov_b32 s45, s25
    s_mov_b32 s46, 3145728
    s_mov_b32 s47, 0x20000
    s_mov_b32 s48, s22
    s_mov_b32 s49, s23
    s_mov_b32 s50, 4096
    s_mov_b32 s51, 0x20000
    s_mov_b32 s52, s4
    s_mov_b32 s53, s5
    s_mov_b32 s54, 4096
    s_mov_b32 s55, 0x20000
    s_cmp_lt_u32 s34, 4
    s_cbranch_scc0 Lm4_3
    buffer_load_dwordx4 v[24:27], v6, s[52:55], s62 offen
    s_branch Lmx_4
Lm4_3:
    buffer_load_ushort v24, v7, s[48:51], s63 offen
Lmx_4:
    buffer_load_dwordx4 v32, s[44:47], s59 offen lds
    s_add_u32 s59, s59, 24576
    s_add_u32 m0, m0, 1024
    s_nop 0
    buffer_load_dwordx4 v33, s[44:47], s59 offen lds
    s_branch L_ROLE_M
L_ENT_W:
    s_sub_u32 s56, s33, 8
    v_lshrrev_b32 v1, 4, v0
    v_lshlrev_b32 v1, 1, v1
    v_and_b32 v2, 7, v0
    v_xor_b32 v1, v1, v2
    v_lshlrev_b32 v1, 4, v1
    v_lshrrev_b32 v2, 3, v0
    v_mul_u32_u24 v2, 8192, v2
    v_add_u32 v32, v1, v2
    s_lshl_b32 s59, s34, 19
    s_lshl_b32 s61, s32, 10
    s_add_u32 s59, s59, s61
    s_lshl_b32 s61, s56, 7
    s_add_u32 s59, s59, s61
    s_lshl_b32 s61, s34, 13
    s_mov_b32 m0, s61
    s_waitcnt lgkmcnt(0)
    s_load_dword s36, s[30:31], 0
    s_mov_b32 s44, s10
    s_mov_b32 s45, s11
    s_mov_b32 s46, 4194304
    s_mov_b32 s47, 0x20000
    s_mov_b32 s38, 8
Ldma_5:
    buffer_load_dwordx4 v32, s[44:47], s59 offen lds
    s_add_u32 s59, s59, 65536
    s_add_u32 m0, m0, 1024
    s_sub_u32 s38, s38, 1
    s_cmp_lg_u32 s38, 0
    s_cbranch_scc1 Ldma_5
    s_branch L_ROLE_W
L_ENT_K:
    s_sub_u32 s56, s33, 16
    s_lshr_b32 s57, s56, 1
    s_and_b32 s58, s56, 1
    s_lshl_b32 s60, s57, 3
    s_add_u32 s60, s60, s32
    s_lshl_b32 s59, s60, 20
    s_add_u32 s59, s59, 786432
    s_lshl_b32 s61, s58, 17
    s_add_u32 s59, s59, s61
    s_lshl_b32 s62, s34, 14
    s_add_u32 s59, s59, s62
    s_mov_b32 m0, s62
    v_lshrrev_b32 v1, 4, v0
    v_and_b32 v2, 15, v0
    v_xor_b32 v3, v1, v2
    v_lshlrev_b32 v3, 4, v3
    v_lshl_add_u32 v32, v1, 8, v3
    v_xor_b32 v4, 64, v3
    v_lshl_add_u32 v33, v1, 8, v4
    v_xor_b32 v4, 128, v3
    v_lshl_add_u32 v34, v1, 8, v4
    v_xor_b32 v4, 192, v3
    v_lshl_add_u32 v35, v1, 8, v4
    s_waitcnt lgkmcnt(0)
    s_load_dword s36, s[30:31], 0
    s_mov_b32 s44, s6
    s_mov_b32 s45, s7
    s_mov_b32 s46, 33554432
    s_mov_b32 s47, 0x20000
    s_waitcnt lgkmcnt(0)
    s_cmp_eq_u32 s34, 0
    s_cbranch_scc0 Lxp_6
    s_mov_b32 s40, s30
    s_mov_b32 s41, s31
    s_mov_b32 s42, 4194304
    s_mov_b32 s43, 0x20000
    s_getreg_b32 s39, hwreg(HW_REG_XCC_ID, 0, 4)
    s_add_u32 s39, s39, s36
    s_add_u32 s39, s39, 2654435769
    v_mov_b32 v209, s39
    s_lshl_b32 s39, s32, 5
    s_add_u32 s39, s39, s33
    s_lshl_b32 s39, s39, 2
    v_mov_b32 v208, s39
    s_mov_b64 exec, 1
    buffer_store_dword v209, v208, s[40:43], 0 offen offset:2048 sc0 sc1
    s_mov_b64 exec, -1
Lxp_6:
    s_mov_b32 s38, 4
Lkdma_7:
    s_waitcnt vmcnt(3)
    buffer_load_dwordx4 v32, s[44:47], s59 offen nt lds
    s_waitcnt vmcnt(3)
    buffer_load_dwordx4 v33, s[44:47], s59 offen offset:1024 nt lds
    s_waitcnt vmcnt(3)
    buffer_load_dwordx4 v34, s[44:47], s59 offen offset:2048 nt lds
    s_waitcnt vmcnt(3)
    buffer_load_dwordx4 v35, s[44:47], s59 offen offset:3072 nt lds
    s_add_u32 s59, s59, 4096
    s_add_u32 m0, m0, 4096
    s_sub_u32 s38, s38, 1
    s_cmp_lg_u32 s38, 0
    s_cbranch_scc1 Lkdma_7
    s_branch L_ROLE_K
L_ENT_V:
    s_sub_u32 s56, s33, 24
    s_lshr_b32 s57, s56, 1
    s_and_b32 s58, s56, 1
    s_lshl_b32 s60, s57, 3
    s_add_u32 s60, s60, s32
    s_lshl_b32 s59, s60, 20
    s_add_u32 s59, s59, 786432
    s_lshl_b32 s61, s58, 7
    s_add_u32 s59, s59, s61
    s_lshl_b32 s61, s34, 15
    s_add_u32 s59, s59, s61
    s_lshl_b32 s62, s34, 14
    s_mov_b32 m0, s62
    v_lshrrev_b32 v1, 4, v0
    v_lshlrev_b32 v1, 1, v1
    v_and_b32 v2, 7, v0
    v_xor_b32 v1, v1, v2
    v_lshlrev_b32 v1, 4, v1
    v_lshrrev_b32 v2, 3, v0
    v_mul_u32_u24 v2, 256, v2
    v_add_u32 v32, v1, v2
    s_waitcnt lgkmcnt(0)
    s_load_dword s36, s[30:31], 0
    s_mov_b32 s44, s8
    s_mov_b32 s45, s9
    s_mov_b32 s46, 33554432
    s_mov_b32 s47, 0x20000
    s_waitcnt lgkmcnt(0)
    s_cmp_eq_u32 s34, 0
    s_cbranch_scc0 Lxp_8
    s_mov_b32 s40, s30
    s_mov_b32 s41, s31
    s_mov_b32 s42, 4194304
    s_mov_b32 s43, 0x20000
    s_getreg_b32 s39, hwreg(HW_REG_XCC_ID, 0, 4)
    s_add_u32 s39, s39, s36
    s_add_u32 s39, s39, 2654435769
    v_mov_b32 v209, s39
    s_lshl_b32 s39, s32, 5
    s_add_u32 s39, s39, s33
    s_lshl_b32 s39, s39, 2
    v_mov_b32 v208, s39
    s_mov_b64 exec, 1
    buffer_store_dword v209, v208, s[40:43], 0 offen offset:2048 sc0 sc1
    s_mov_b64 exec, -1
Lxp_8:
    s_cmp_eq_u32 s58, 1
    s_cselect_b32 s63, 2, 3
    s_sub_u32 s66, 16, s63
    s_mov_b32 s38, s63
Ldma_9:
    s_waitcnt vmcnt(0)
    buffer_load_dwordx4 v32, s[44:47], s59 offen nt lds
    s_add_u32 s59, s59, 2048
    s_add_u32 m0, m0, 1024
    s_sub_u32 s38, s38, 1
    s_cmp_lg_u32 s38, 0
    s_cbranch_scc1 Ldma_9
    s_mov_b32 s38, s66
Ldma_10:
    buffer_load_dwordx4 v32, s[44:47], s59 offen nt lds
    s_add_u32 s59, s59, 2048
    s_add_u32 m0, m0, 1024
    s_sub_u32 s38, s38, 1
    s_cmp_lg_u32 s38, 0
    s_cbranch_scc1 Ldma_10
    s_branch L_ROLE_V
L_ROLE_M:
    s_mov_b32 s40, s30
    s_mov_b32 s41, s31
    s_mov_b32 s42, 4194304
    s_mov_b32 s43, 0x20000
    s_waitcnt lgkmcnt(0)
    s_cmp_eq_u32 s34, 0
    s_cbranch_scc0 Lxp_11
    s_getreg_b32 s39, hwreg(HW_REG_XCC_ID, 0, 4)
    s_add_u32 s39, s39, s36
    s_add_u32 s39, s39, 2654435769
    v_mov_b32 v209, s39
    s_lshl_b32 s39, s32, 5
    s_add_u32 s39, s39, s33
    s_lshl_b32 s39, s39, 2
    v_mov_b32 v208, s39
    s_mov_b64 exec, 1
    buffer_store_dword v209, v208, s[40:43], 0 offen offset:2048 sc0 sc1
    s_mov_b64 exec, -1
Lxp_11:
    v_bfe_u32 v1, v0, 1, 2
    v_lshlrev_b32 v1, 10, v1
    v_and_b32 v2, 1, v0
    v_lshl_add_u32 v1, v2, 3, v1
    v_lshrrev_b32 v2, 4, v0
    v_lshl_add_u32 v1, v2, 1, v1
    s_lshl_b32 s61, s32, 7
    s_lshl_b32 s56, s33, 4
    s_add_u32 s61, s61, s56
    buffer_load_ushort v28, v1, s[52:55], s61 offen
    s_cmp_eq_u32 s34, 4
    s_cbranch_scc0 Lmt0_12
    s_lshl_b32 s61, s32, 3
    s_add_u32 s61, s61, s33
    s_lshl_b32 s61, s61, 12
    s_add_u32 s61, s61, 2101248
    v_lshlrev_b32 v2, 4, v0
    buffer_load_dwordx4 v[64:67], v2, s[40:43], s61 offen sc1
    buffer_load_dwordx4 v[68:71], v2, s[40:43], s61 offen offset:1024 sc1
    buffer_load_dwordx4 v[72:75], v2, s[40:43], s61 offen offset:2048 sc1
    buffer_load_dwordx4 v[76:79], v2, s[40:43], s61 offen offset:3072 sc1
Lmt0_12:
    v_lshrrev_b32 v1, 4, v0
    v_bfe_u32 v2, v0, 2, 2
    v_lshl_add_u32 v3, v1, 2, v2
    v_lshlrev_b32 v34, 8, v3
    v_and_b32 v3, 1, v1
    v_lshlrev_b32 v3, 3, v3
    v_lshl_add_u32 v3, v2, 1, v3
    s_lshl_b32 s61, s34, 1
    v_xor_b32 v3, s61, v3
    v_lshl_add_u32 v34, v3, 4, v34
    v_and_b32 v3, 3, v0
    v_lshl_add_u32 v34, v3, 3, v34
    v_and_b32 v1, 3, v0
    v_mul_u32_u24 v35, 160, v1
    v_lshrrev_b32 v1, 4, v0
    v_lshl_add_u32 v35, v1, 4, v35
    v_add_u32 v35, 16384, v35
    v_lshrrev_b32 v1, 5, v0
    v_lshlrev_b32 v36, 12, v1
    v_bfe_u32 v1, v0, 2, 1
    v_lshl_add_u32 v36, v1, 10, v36
    v_and_b32 v1, 3, v0
    v_lshl_add_u32 v36, v1, 5, v36
    v_bfe_u32 v1, v0, 4, 1
    v_lshl_add_u32 v36, v1, 4, v36
    s_lshl_b32 s60, s32, 15
    s_and_b32 s61, s34, 3
    s_lshl_b32 s61, s61, 13
    s_add_u32 s60, s60, s61
    s_lshr_b32 s61, s34, 2
    s_lshl_b32 s61, s61, 11
    s_add_u32 s60, s60, s61
    s_lshl_b32 s61, s33, 7
    s_add_u32 s60, s60, s61
    s_add_u32 s60, s60, 4096
    s_cmp_ge_u32 s34, 4
    s_cbranch_scc0 Lmb_13
    v_lshrrev_b32 v4, 2, v0
    v_lshrrev_b32 v5, 3, v4
    v_lshlrev_b32 v5, 6, v5
    v_and_b32 v6, 3, v4
    v_lshl_add_u32 v5, v6, 4, v5
    v_bfe_u32 v6, v4, 2, 1
    v_lshl_add_u32 v5, v6, 3, v5
    v_and_b32 v6, 3, v0
    v_lshl_add_u32 v5, v6, 1, v5
    s_and_b32 s61, s34, 3
    s_mul_i32 s61, s61, 160
    s_add_u32 s61, s61, 16384
    v_add_u32 v5, s61, v5
    s_cmp_eq_u32 s34, 4
    s_cbranch_scc1 Lmc7_15
    s_waitcnt vmcnt(3)
Lmc7_15:
    s_waitcnt vmcnt(7)
    v_lshlrev_b32 v8, 16, v24
    s_mov_b32 s94, 0xbfb8aa3b
    s_mov_b32 s95, 0xb2a57060
    v_mul_f32 v12, 0xbfb8aa3b, v8
    v_fma_f32 v13, v8, s94, -v12
    v_fma_f32 v13, v8, s95, v13
    v_exp_f32 v12, v12
    v_mul_f32 v13, 0x3f317218, v13
    v_add_f32 v13, 1.0, v13
    v_mul_f32 v12, v12, v13
    v_add_f32 v12, 1.0, v12
    v_rcp_f32 v13, v12
    v_cmp_eq_f32 vcc, 0x7f800000, v12
    v_mul_f32 v14, v8, v13
    v_fma_f32 v15, -v14, v12, v8
    v_fma_f32 v15, v15, v13, v14
    v_cndmask_b32 v8, v15, v14, vcc
    v_cvt_pk_bf16_f32 v8, v8, v8
    ds_write_b16 v5, v8
Lmb_13:
    s_waitcnt vmcnt(0) lgkmcnt(0)
    s_barrier
    ds_read_b64_tr_b16 v[64:65], v34 offset:0
    ds_read_b64_tr_b16 v[66:67], v34 offset:4096
    ds_read_b64_tr_b16 v[68:69], v34 offset:8192
    ds_read_b64_tr_b16 v[70:71], v34 offset:12288
    ds_read_b128 v[72:75], v35
    ds_read_b128 v[76:79], v35 offset:64
    s_add_u32 s35, s36, 2654435769
    s_waitcnt lgkmcnt(0)
    v_mfma_f32_16x16x32_bf16 v[4:7], v[64:67], v[72:75], 0
    v_mfma_f32_16x16x32_bf16 v[4:7], v[68:71], v[76:79], v[4:7]
    s_mov_b32 exec_lo, 0x00f000f0
    s_mov_b32 exec_hi, 0x00f000f0
    s_nop 5
    v_mov_b32 v4, v6
    v_mov_b32 v5, v7
    s_mov_b32 exec_lo, 0x00ff00ff
    s_mov_b32 exec_hi, 0x00ff00ff
    v_mov_b32 v6, s35
    v_mov_b32 v7, 0
    s_or_b32 s39, s60, 2097152
    buffer_store_dwordx4 v[4:7], v36, s[40:43], s39 offen
    s_mov_b64 exec, -1
    s_cmp_eq_u32 s34, 4
    s_cbranch_scc1 Lmh4_17
    s_cmp_lt_u32 s34, 4
    s_cbranch_scc0 Lms_16
    v_lshlrev_b32 v8, 16, v24
    v_and_b32 v9, 0xffff0000, v24
    v_lshlrev_b32 v10, 16, v25
    v_and_b32 v11, 0xffff0000, v25
    v_lshlrev_b32 v12, 16, v26
    v_and_b32 v13, 0xffff0000, v26
    v_lshlrev_b32 v14, 16, v27
    v_and_b32 v15, 0xffff0000, v27
    v_add_f32 v16, v8, v9
    v_add_f32 v17, v10, v11
    v_add_f32 v18, v12, v13
    v_add_f32 v19, v14, v15
    v_add_f32 v16, v16, v17
    v_add_f32 v18, v18, v19
    v_add_f32 v16, v16, v18
    s_nop 1
    v_add_f32_dpp v16, v16, v16 quad_perm:[1,0,3,2] row_mask:0xf bank_mask:0xf
    s_nop 1
    v_add_f32_dpp v16, v16, v16 quad_perm:[2,3,0,1] row_mask:0xf bank_mask:0xf
    s_nop 1
    v_add_f32_dpp v16, v16, v16 row_half_mirror row_mask:0xf bank_mask:0xf
    s_nop 1
    v_add_f32_dpp v16, v16, v16 row_mirror row_mask:0xf bank_mask:0xf
    v_mov_b32 v17, v16
    s_nop 1
    v_permlane16_swap_b32 v16, v17
    v_add_f32 v16, v16, v17
    v_mov_b32 v17, v16
    s_nop 1
    v_permlane32_swap_b32 v16, v17
    v_add_f32 v16, v16, v17
    v_mul_f32 v16, 0x3b000000, v16
    v_sub_f32 v17, v8, v16
    v_mul_f32 v18, v17, v17
    v_sub_f32 v19, v9, v16
    v_fmac_f32 v18, v19, v19
    v_sub_f32 v17, v10, v16
    v_fmac_f32 v18, v17, v17
    v_sub_f32 v19, v11, v16
    v_fmac_f32 v18, v19, v19
    v_sub_f32 v17, v12, v16
    v_fmac_f32 v18, v17, v17
    v_sub_f32 v19, v13, v16
    v_fmac_f32 v18, v19, v19
    v_sub_f32 v17, v14, v16
    v_fmac_f32 v18, v17, v17
    v_sub_f32 v19, v15, v16
    v_fmac_f32 v18, v19, v19
    s_nop 1
    v_add_f32_dpp v18, v18, v18 quad_perm:[1,0,3,2] row_mask:0xf bank_mask:0xf
    s_nop 1
    v_add_f32_dpp v18, v18, v18 quad_perm:[2,3,0,1] row_mask:0xf bank_mask:0xf
    s_nop 1
    v_add_f32_dpp v18, v18, v18 row_half_mirror row_mask:0xf bank_mask:0xf
    s_nop 1
    v_add_f32_dpp v18, v18, v18 row_mirror row_mask:0xf bank_mask:0xf
    v_mov_b32 v17, v18
    s_nop 1
    v_permlane16_swap_b32 v18, v17
    v_add_f32 v18, v18, v17
    v_mov_b32 v17, v18
    s_nop 1
    v_permlane32_swap_b32 v18, v17
    v_add_f32 v18, v18, v17
    v_mul_f32 v18, 0x3b000000, v18
    v_cvt_pk_bf16_f32 v18, v18, v18
    v_and_b32 v18, 0xffff0000, v18
    v_add_f32 v18, 0x3727c5ac, v18
    v_cvt_pk_bf16_f32 v18, v18, v18
    v_and_b32 v18, 0xffff0000, v18
    v_sqrt_f32 v18, v18
    s_nop 0
    v_cvt_pk_bf16_f32 v21, v18, v18
    v_and_b32 v21, 0xffff0000, v21
    v_cvt_pk_bf16_f32 v20, v16, v16
    v_and_b32 v20, 0xffff0000, v20
    v_rcp_f32 v22, v21
    s_lshl_b32 s61, s34, 3
    s_add_u32 s61, s61, 17024
    v_mov_b32 v1, s61
    s_mov_b64 exec, 1
    ds_write_b64 v1, v[20:21]
    s_mov_b64 exec, -1
    s_waitcnt lgkmcnt(0)
Lms_16:
    s_mov_b32 exec_lo, 0x00ff00ff
    s_mov_b32 exec_hi, 0x00ff00ff
    buffer_store_dwordx4 v[4:7], v36, s[40:43], s60 offen sc0 sc1
    s_mov_b64 exec, -1
    s_barrier
    s_branch Lmh_18
Lmh4_17:
    s_mov_b32 exec_lo, 0x00ff00ff
    s_mov_b32 exec_hi, 0x00ff00ff
    buffer_store_dwordx4 v[4:7], v36, s[40:43], s60 offen sc0 sc1
    s_mov_b64 exec, -1
    v_bfe_u32 v1, v0, 1, 2
    v_lshlrev_b32 v1, 3, v1
    v_add_u32 v1, 17024, v1
    v_lshlrev_b32 v28, 16, v28
    s_lshl_b32 s59, s32, 3
    s_add_u32 s59, s59, s33
    s_lshl_b32 s57, s59, 7
    s_add_u32 s57, s57, 266240
    s_lshl_b32 s59, s59, 12
    s_add_u32 s59, s59, 4096
    v_lshlrev_b32 v2, 4, v0
    s_or_b32 s59, s59, 2097152
    s_mov_b32 s37, 100000
LA1_20:
    buffer_load_dwordx4 v[4:7], v2, s[40:43], s59 offen sc1
    buffer_load_dwordx4 v[8:11], v2, s[40:43], s59 offen offset:1024 sc1
    buffer_load_dwordx4 v[12:15], v2, s[40:43], s59 offen offset:2048 sc1
    buffer_load_dwordx4 v[16:19], v2, s[40:43], s59 offen offset:3072 sc1
    s_waitcnt vmcnt(0)
    v_cmp_ne_u32 vcc, s35, v6
    v_cmp_ne_u32 s[64:65], s35, v10
    s_nop 0
    s_or_b64 vcc, vcc, s[64:65]
    v_cmp_ne_u32 s[64:65], s35, v14
    s_nop 0
    s_or_b64 vcc, vcc, s[64:65]
    v_cmp_ne_u32 s[64:65], s35, v18
    s_nop 0
    s_or_b64 vcc, vcc, s[64:65]
    s_cbranch_scc0 LA1ok_19
    s_cmp_lt_u32 s37, 99800
    s_cselect_b32 s39, 2097152, 0
    s_xor_b32 s59, s59, s39
    s_sub_u32 s37, s37, 1
    s_cbranch_scc0 LA1_20
LA1ok_19:
    s_barrier
    ds_read_b64 v[20:21], v1
    v_mov_b32 v6, v8
    v_mov_b32 v7, v9
    v_mov_b32 v14, v16
    v_mov_b32 v15, v17
    v_add_f32_dpp v4, v4, v4 row_ror:8 row_mask:0xf bank_mask:0xf
    v_add_f32_dpp v5, v5, v5 row_ror:8 row_mask:0xf bank_mask:0xf
    v_add_f32_dpp v6, v6, v6 row_ror:8 row_mask:0xf bank_mask:0xf
    v_add_f32_dpp v7, v7, v7 row_ror:8 row_mask:0xf bank_mask:0xf
    v_add_f32_dpp v12, v12, v12 row_ror:8 row_mask:0xf bank_mask:0xf
    v_add_f32_dpp v13, v13, v13 row_ror:8 row_mask:0xf bank_mask:0xf
    v_add_f32_dpp v14, v14, v14 row_ror:8 row_mask:0xf bank_mask:0xf
    v_add_f32_dpp v15, v15, v15 row_ror:8 row_mask:0xf bank_mask:0xf
    v_permlane16_swap_b32 v4, v5
    v_permlane16_swap_b32 v6, v7
    v_permlane16_swap_b32 v12, v13
    v_permlane16_swap_b32 v14, v15
    v_add_f32 v4, v4, v5
    v_add_f32 v6, v6, v7
    v_add_f32 v12, v12, v13
    v_add_f32 v14, v14, v15
    v_permlane32_swap_b32 v4, v6
    s_nop 0
    v_permlane32_swap_b32 v12, v14
    v_add_f32 v4, v4, v6
    v_add_f32 v12, v12, v14
    s_waitcnt lgkmcnt(0)
    v_rcp_f32 v22, v21
    v_cvt_pk_bf16_f32 v4, v4, v12
    v_and_b32 v12, 0xffff0000, v4
    v_lshlrev_b32 v4, 16, v4
    v_add_f32 v12, 1.0, v12
    v_sub_f32 v23, v28, v20
    v_cvt_pk_bf16_f32 v23, v23, v23
    v_and_b32 v23, 0xffff0000, v23
    v_mul_f32 v29, v23, v22
    v_fma_f32 v30, -v29, v21, v23
    v_fma_f32 v29, v30, v22, v29
    v_cvt_pk_bf16_f32 v29, v29, v29
    v_and_b32 v29, 0xffff0000, v29
    v_mov_b32 v22, s35
    v_mov_b32 v23, 0
    v_cvt_pk_bf16_f32 v12, v12, v12
    v_and_b32 v12, 0xffff0000, v12
    v_mul_f32 v12, v29, v12
    v_cvt_pk_bf16_f32 v12, v12, v12
    v_and_b32 v12, 0xffff0000, v12
    v_add_f32 v12, v12, v4
    v_mov_b32 v20, v12
    v_mov_b32 v8, v12
    s_nop 1
    v_permlane16_swap_b32 v20, v8
    v_cvt_pk_bf16_f32 v20, v20, v8
    v_mov_b32 v21, v20
    s_nop 1
    v_permlane32_swap_b32 v20, v21
    s_mov_b64 exec, 0xff
    buffer_store_dwordx4 v[20:23], v2, s[40:43], s57 offen sc0 sc1
    s_mov_b64 exec, -1
Lmh_18:
    s_cmp_eq_u32 s33, 7
    s_cbranch_scc1 L_ROLE_GA
    s_mul_i32 s66, s32, 7
    s_add_u32 s66, s66, s33
    s_mov_b32 s44, s16
    s_mov_b32 s45, s17
    s_mov_b32 s46, 1835008
    s_mov_b32 s47, 0x20000
    s_mov_b32 s48, s18
    s_mov_b32 s49, s19
    s_mov_b32 s50, 1835008
    s_mov_b32 s51, 0x20000
    s_mov_b32 s52, s20
    s_mov_b32 s53, s21
    s_mov_b32 s54, 1835008
    s_mov_b32 s55, 0x20000
    v_lshrrev_b32 v1, 2, v0
    v_mul_u32_u24 v1, 3584, v1
    v_bfe_u32 v2, v0, 4, 1
    v_lshlrev_b32 v2, 1, v2
    v_and_b32 v3, 3, v0
    v_xor_b32 v2, v2, v3
    v_lshl_add_u32 v32, v2, 4, v1
    v_xor_b32 v2, 1, v2
    v_lshl_add_u32 v31, v2, 4, v1
    s_lshl_b32 s59, s34, 6
    s_mul_i32 s59, s59, 3584
    s_lshl_b32 s61, s66, 6
    s_add_u32 s59, s59, s61
    s_mov_b32 s60, s59
    s_lshl_b32 s67, s66, 5
    s_lshl_b32 s61, s34, 2
    s_add_u32 s67, s67, s61
    s_lshl_b32 s67, s67, 10
    s_and_b32 s62, s34, 1
    s_lshl_b32 s62, s62, 3
    s_add_u32 s63, s62, 0
    v_xor_b32 v1, s63, v0
    v_lshlrev_b32 v40, 4, v1
    s_add_u32 s63, s62, 2
    v_xor_b32 v1, s63, v0
    v_lshlrev_b32 v41, 4, v1
    s_add_u32 s63, s62, 4
    v_xor_b32 v1, s63, v0
    v_lshlrev_b32 v42, 4, v1
    s_add_u32 s63, s62, 6
    v_xor_b32 v1, s63, v0
    v_lshlrev_b32 v43, 4, v1
    v_lshrrev_b32 v1, 4, v0
    v_bfe_u32 v2, v0, 2, 2
    v_lshl_add_u32 v3, v1, 2, v2
    v_lshlrev_b32 v33, 6, v3
    v_and_b32 v3, 1, v1
    v_lshlrev_b32 v3, 1, v3
    s_and_b32 s61, s34, 3
    v_xor_b32 v3, s61, v3
    v_bfe_u32 v4, v0, 1, 1
    v_xor_b32 v3, v3, v4
    v_lshl_add_u32 v33, v3, 4, v33
    v_lshl_add_u32 v33, v4, 15, v33
    v_and_b32 v3, 1, v0
    v_lshl_add_u32 v33, v3, 3, v33
    v_add_u32 v33, 32768, v33
    v_lshl_add_u32 v3, v1, 2, v2
    v_lshlrev_b32 v4, 10, v3
    v_and_b32 v5, 3, v0
    v_lshl_add_u32 v4, v5, 3, v4
    v_add_u32 v4, 98304, v4
    v_and_b32 v3, 7, v3
    v_lshlrev_b32 v3, 1, v3
    s_lshl_b32 s61, s34, 3
    v_xor_b32 v3, s61, v3
    v_xor_b32 v5, 0, v3
    v_lshl_add_u32 v34, v5, 4, v4
    v_xor_b32 v5, 2, v3
    v_lshl_add_u32 v35, v5, 4, v4
    v_xor_b32 v5, 4, v3
    v_lshl_add_u32 v36, v5, 4, v4
    v_xor_b32 v5, 6, v3
    v_lshl_add_u32 v37, v5, 4, v4
    v_and_b32 v1, 3, v0
    v_mul_u32_u24 v38, 1056, v1
    v_lshrrev_b32 v1, 4, v0
    v_lshl_add_u32 v38, v1, 4, v38
    v_add_u32 v38, 131072, v38
    v_and_b32 v1, 3, v0
    v_mul_u32_u24 v39, 96, v1
    v_lshrrev_b32 v1, 4, v0
    v_lshl_add_u32 v39, v1, 4, v39
    v_add_u32 v39, 135296, v39
    v_lshlrev_b32 v44, 4, v0
    s_lshl_b32 s68, s32, 2
    s_add_u32 s68, s68, s34
    s_lshl_b32 s68, s68, 12
    s_add_u32 s68, s68, 1060864
    v_lshrrev_b32 v45, 3, v0
    v_lshlrev_b32 v45, 6, v45
    v_and_b32 v1, 3, v0
    v_lshl_add_u32 v45, v1, 4, v45
    v_bfe_u32 v1, v0, 2, 1
    v_lshl_add_u32 v45, v1, 3, v45
    s_mul_i32 s61, s34, 1056
    s_add_u32 s61, s61, 131072
    v_add_u32 v45, s61, v45
    v_and_b32 v1, 3, v0
    v_mul_u32_u24 v46, 96, v1
    v_lshrrev_b32 v1, 4, v0
    s_lshl_b32 s61, s34, 1
    v_add_u32 v1, s61, v1
    v_and_b32 v2, 3, v1
    v_lshl_add_u32 v46, v2, 4, v46
    v_bfe_u32 v2, v1, 2, 1
    v_lshl_add_u32 v46, v2, 3, v46
    v_add_u32 v46, 135296, v46
    v_bfe_u32 v1, v0, 2, 2
    v_lshlrev_b32 v1, 1, v1
    v_lshrrev_b32 v2, 5, v0
    v_add_u32 v1, v1, v2
    v_mul_u32_u24 v47, 7168, v1
    v_and_b32 v1, 3, v0
    v_lshl_add_u32 v47, v1, 5, v47
    v_bfe_u32 v1, v0, 4, 1
    v_lshl_add_u32 v47, v1, 4, v47
    s_mul_i32 s63, s34, 57344
    s_lshl_b32 s61, s66, 7
    s_add_u32 s63, s63, s61
    s_add_u32 s63, s63, 1191936
    s_mov_b32 s92, 0x0c0c0400
    s_mov_b32 s93, 0x04000c0c
    s_movk_i32 s91, 0xff
    v_mov_b32 v48, s35
    v_lshrrev_b32 v49, 8, v48
    v_lshrrev_b32 v50, 16, v48
    v_lshrrev_b32 v51, 24, v48
    s_lshr_b32 s61, s66, 1
    s_and_b32 s61, s61, 3
    s_cmp_eq_u32 s61, 3
    s_cbranch_scc1 Lmt_21
    s_cmp_eq_u32 s34, 0
    s_cbranch_scc0 Lmt_21
    v_lshlrev_b32 v2, 10, v0
    s_lshl_b32 s61, s32, 13
    s_add_u32 s61, s61, 274432
    s_mov_b64 exec, 0xff
    s_or_b32 s61, s61, 2097152
    s_mov_b32 s37, 100000
LT_23:
    buffer_load_dwordx4 v[4:7], v2, s[40:43], s61 offen sc1
    s_waitcnt vmcnt(0)
    v_cmp_ne_u32 vcc, s35, v6
    s_cbranch_vccz LTok_22
    s_cmp_lt_u32 s37, 99800
    s_cselect_b32 s39, 2097152, 0
    s_xor_b32 s61, s61, s39
    s_sub_u32 s37, s37, 1
    s_cbranch_scc0 LT_23
LTok_22:
    s_mov_b64 exec, -1
Lmt_21:
    s_barrier
    s_lshl_b32 s61, s34, 12
    s_add_u32 s61, s61, 32768
    s_mov_b32 m0, s61
    s_mov_b32 s38, 4
Ldma_24:
    buffer_load_dwordx4 v32, s[44:47], s59 offen lds
    s_add_u32 s59, s59, 57344
    s_add_u32 m0, m0, 1024
    s_sub_u32 s38, s38, 1
    s_cmp_lg_u32 s38, 0
    s_cbranch_scc1 Ldma_24
    s_sub_u32 s61, s61, 0
    s_add_u32 s61, s61, 32768
    s_mov_b32 m0, s61
    s_mov_b32 s38, 4
Ldma_25:
    buffer_load_dwordx4 v31, s[48:51], s60 offen lds
    s_add_u32 s60, s60, 57344
    s_add_u32 m0, m0, 1024
    s_sub_u32 s38, s38, 1
    s_cmp_lg_u32 s38, 0
    s_cbranch_scc1 Ldma_25
    s_add_u32 s61, s61, 32768
    s_mov_b32 m0, s61
    s_nop 0
    buffer_load_dwordx4 v40, s[52:55], s67 offen lds
    s_add_u32 s67, s67, 1024
    s_add_u32 m0, m0, 1024
    s_nop 0
    buffer_load_dwordx4 v41, s[52:55], s67 offen lds
    s_add_u32 s67, s67, 1024
    s_add_u32 m0, m0, 1024
    s_nop 0
    buffer_load_dwordx4 v42, s[52:55], s67 offen lds
    s_add_u32 s67, s67, 1024
    s_add_u32 m0, m0, 1024
    s_nop 0
    buffer_load_dwordx4 v43, s[52:55], s67 offen lds
    s_add_u32 s67, s67, 1024
    s_add_u32 m0, m0, 1024
    s_nop 0
    s_waitcnt vmcnt(0)
    s_barrier
    ds_read_b64_tr_b16 v[128:129], v34 offset:0
    ds_read_b64_tr_b16 v[130:131], v34 offset:16384
    ds_read_b64_tr_b16 v[132:133], v35 offset:0
    ds_read_b64_tr_b16 v[134:135], v35 offset:16384
    ds_read_b64_tr_b16 v[136:137], v36 offset:0
    ds_read_b64_tr_b16 v[138:139], v36 offset:16384
    ds_read_b64_tr_b16 v[140:141], v37 offset:0
    ds_read_b64_tr_b16 v[142:143], v37 offset:16384
    s_cmp_lt_u32 s34, 4
    s_cbranch_scc0 Lmw_26
    s_waitcnt lgkmcnt(0)
    ds_read_b64_tr_b16 v[64:65], v33 offset:0
    ds_read_b64_tr_b16 v[66:67], v33 offset:1024
    ds_read_b64_tr_b16 v[68:69], v33 offset:2048
    ds_read_b64_tr_b16 v[70:71], v33 offset:3072
    ds_read_b64_tr_b16 v[72:73], v33 offset:4096
    ds_read_b64_tr_b16 v[74:75], v33 offset:5120
    ds_read_b64_tr_b16 v[76:77], v33 offset:6144
    ds_read_b64_tr_b16 v[78:79], v33 offset:7168
    ds_read_b64_tr_b16 v[80:81], v33 offset:8192
    ds_read_b64_tr_b16 v[82:83], v33 offset:9216
    ds_read_b64_tr_b16 v[84:85], v33 offset:10240
    ds_read_b64_tr_b16 v[86:87], v33 offset:11264
    ds_read_b64_tr_b16 v[88:89], v33 offset:12288
    ds_read_b64_tr_b16 v[90:91], v33 offset:13312
    s_waitcnt lgkmcnt(6)
    ds_read_b64_tr_b16 v[92:93], v33 offset:14336
    ds_read_b64_tr_b16 v[94:95], v33 offset:15360
    ds_read_b64_tr_b16 v[96:97], v33 offset:16384
    ds_read_b64_tr_b16 v[98:99], v33 offset:17408
    ds_read_b64_tr_b16 v[100:101], v33 offset:18432
    ds_read_b64_tr_b16 v[102:103], v33 offset:19456
    ds_read_b64_tr_b16 v[104:105], v33 offset:20480
    ds_read_b64_tr_b16 v[106:107], v33 offset:21504
    s_waitcnt lgkmcnt(6)
    ds_read_b64_tr_b16 v[108:109], v33 offset:22528
    ds_read_b64_tr_b16 v[110:111], v33 offset:23552
    ds_read_b64_tr_b16 v[112:113], v33 offset:24576
    ds_read_b64_tr_b16 v[114:115], v33 offset:25600
    ds_read_b64_tr_b16 v[116:117], v33 offset:26624
    ds_read_b64_tr_b16 v[118:119], v33 offset:27648
    ds_read_b64_tr_b16 v[120:121], v33 offset:28672
    ds_read_b64_tr_b16 v[122:123], v33 offset:29696
    ds_read_b64_tr_b16 v[124:125], v33 offset:30720
    ds_read_b64_tr_b16 v[126:127], v33 offset:31744
    s_or_b32 s68, s68, 2097152
    s_mov_b32 s37, 100000
LD_28:
    buffer_load_dwordx4 v[4:7], v44, s[40:43], s68 offen sc1
    buffer_load_dwordx4 v[8:11], v44, s[40:43], s68 offen offset:2048 sc1
    buffer_load_dwordx4 v[12:15], v44, s[40:43], s68 offen offset:1024 sc1
    buffer_load_dwordx4 v[16:19], v44, s[40:43], s68 offen offset:3072 sc1
    s_waitcnt vmcnt(0)
    v_cmp_ne_u32 vcc, s35, v7
    v_cmp_ne_u32 s[64:65], s35, v11
    s_nop 0
    s_or_b64 vcc, vcc, s[64:65]
    v_cmp_ne_u32 s[64:65], s35, v15
    s_nop 0
    s_or_b64 vcc, vcc, s[64:65]
    v_cmp_ne_u32 s[64:65], s35, v19
    s_nop 0
    s_or_b64 vcc, vcc, s[64:65]
    s_cbranch_scc0 LDok_27
    s_cmp_lt_u32 s37, 99800
    s_cselect_b32 s39, 2097152, 0
    s_xor_b32 s68, s68, s39
    s_sub_u32 s37, s37, 1
    s_cbranch_scc0 LD_28
LDok_27:
    v_lshlrev_b32 v20, 16, v4
    v_and_b32 v21, 0xffff0000, v4
    v_lshlrev_b32 v22, 16, v5
    v_and_b32 v23, 0xffff0000, v5
    v_lshlrev_b32 v24, 16, v12
    v_and_b32 v25, 0xffff0000, v12
    v_lshlrev_b32 v26, 16, v13
    v_and_b32 v27, 0xffff0000, v13
    v_readfirstlane_b32 s39, v20
    v_lshlrev_b32 v156, 16, v6
    v_and_b32 v157, 0xffff0000, v6
    v_lshlrev_b32 v158, 16, v8
    v_and_b32 v159, 0xffff0000, v8
    v_lshlrev_b32 v160, 16, v14
    v_and_b32 v161, 0xffff0000, v14
    v_lshlrev_b32 v162, 16, v16
    v_and_b32 v163, 0xffff0000, v16
    v_subrev_f32 v148, s39, v20
    v_subrev_f32 v149, s39, v21
    v_subrev_f32 v150, s39, v22
    v_subrev_f32 v151, s39, v23
    v_subrev_f32 v152, s39, v24
    v_subrev_f32 v153, s39, v25
    v_subrev_f32 v154, s39, v26
    v_subrev_f32 v155, s39, v27
    v_add_f32 v144, v148, v149
    v_mul_f32 v145, v148, v148
    v_add_f32 v146, v150, v151
    v_mul_f32 v147, v149, v149
    v_add_f32 v144, v144, v146
    v_fmac_f32 v145, v150, v150
    v_add_f32 v146, v152, v153
    v_fmac_f32 v147, v151, v151
    v_add_f32 v144, v144, v146
    v_fmac_f32 v145, v152, v152
    v_add_f32 v146, v154, v155
    v_fmac_f32 v147, v153, v153
    v_add_f32 v144, v144, v146
    v_fmac_f32 v145, v154, v154
    v_fmac_f32 v147, v155, v155
    v_add_f32 v145, v145, v147
    v_add_f32_dpp v144, v144, v144 quad_perm:[1,0,3,2] row_mask:0xf bank_mask:0xf
    s_nop 0
    v_add_f32_dpp v145, v145, v145 quad_perm:[1,0,3,2] row_mask:0xf bank_mask:0xf
    v_lshlrev_b32 v164, 16, v9
    v_add_f32_dpp v144, v144, v144 quad_perm:[2,3,0,1] row_mask:0xf bank_mask:0xf
    v_add_f32_dpp v145, v145, v145 quad_perm:[2,3,0,1] row_mask:0xf bank_mask:0xf
    v_and_b32 v165, 0xffff0000, v9
    v_add_f32_dpp v144, v144, v144 row_half_mirror row_mask:0xf bank_mask:0xf
    v_add_f32_dpp v145, v145, v145 row_half_mirror row_mask:0xf bank_mask:0xf
    v_lshlrev_b32 v166, 16, v10
    v_add_f32_dpp v144, v144, v144 row_mirror row_mask:0xf bank_mask:0xf
    v_add_f32_dpp v145, v145, v145 row_mirror row_mask:0xf bank_mask:0xf
    v_and_b32 v167, 0xffff0000, v10
    v_mov_b32 v146, v144
    v_mov_b32 v147, v145
    v_lshlrev_b32 v168, 16, v17
    v_permlane16_swap_b32 v144, v146
    v_permlane16_swap_b32 v145, v147
    v_add_f32 v144, v144, v146
    v_add_f32 v145, v145, v147
    v_mov_b32 v146, v144
    v_mov_b32 v147, v145
    v_and_b32 v169, 0xffff0000, v17
    v_permlane32_swap_b32 v144, v146
    v_permlane32_swap_b32 v145, v147
    v_add_f32 v144, v144, v146
    v_add_f32 v145, v145, v147
    v_lshlrev_b32 v170, 16, v18
    v_and_b32 v171, 0xffff0000, v18
    v_mul_f32 v52, 0x3b000000, v144
    v_mul_f32 v145, 0x3b000000, v145
    v_fma_f32 v145, -v52, v52, v145
    v_mov_b32 v53, v52
    v_max_f32 v145, 0, v145
    v_add_f32 v145, 0x3727c5ac, v145
    v_rsq_f32 v54, v145
    v_pk_add_f32 v[148:149], v[148:149], v[52:53] neg_lo:[0,1] neg_hi:[0,1]
    v_pk_add_f32 v[150:151], v[150:151], v[52:53] neg_lo:[0,1] neg_hi:[0,1]
    v_pk_add_f32 v[152:153], v[152:153], v[52:53] neg_lo:[0,1] neg_hi:[0,1]
    v_pk_add_f32 v[154:155], v[154:155], v[52:53] neg_lo:[0,1] neg_hi:[0,1]
    v_mov_b32 v55, v54
    v_pk_mul_f32 v[156:157], v[156:157], v[54:55]
    v_pk_mul_f32 v[158:159], v[158:159], v[54:55]
    v_pk_mul_f32 v[160:161], v[160:161], v[54:55]
    v_pk_mul_f32 v[162:163], v[162:163], v[54:55]
    v_pk_fma_f32 v[148:149], v[148:149], v[156:157], v[164:165]
    v_pk_fma_f32 v[150:151], v[150:151], v[158:159], v[166:167]
    v_pk_fma_f32 v[152:153], v[152:153], v[160:161], v[168:169]
    v_pk_fma_f32 v[154:155], v[154:155], v[162:163], v[170:171]
    v_cvt_pk_bf16_f32 v4, v148, v149
    v_cvt_pk_bf16_f32 v5, v150, v151
    v_cvt_pk_bf16_f32 v6, v152, v153
    v_cvt_pk_bf16_f32 v7, v154, v155
    ds_write_b64 v45, v[4:5]
    ds_write_b64 v45, v[6:7] offset:512
Lmw_26:
    s_waitcnt lgkmcnt(0)
    s_barrier
    s_cmp_lt_u32 s34, 4
    s_cbranch_scc0 Lmg_29
    ds_read_b128 v[144:147], v38 offset:0
    ds_read_b128 v[148:151], v38 offset:64
    ds_read_b128 v[152:155], v38 offset:128
    ds_read_b128 v[156:159], v38 offset:192
    ds_read_b128 v[160:163], v38 offset:256
    ds_read_b128 v[164:167], v38 offset:320
    ds_read_b128 v[168:171], v38 offset:384
    ds_read_b128 v[172:175], v38 offset:448
    ds_read_b128 v[176:179], v38 offset:512
    s_waitcnt lgkmcnt(8)
    v_mfma_f32_16x16x32_bf16 v[4:7], v[64:67], v[144:147], 0
    ds_read_b128 v[180:183], v38 offset:576
    s_waitcnt lgkmcnt(8)
    v_mfma_f32_16x16x32_bf16 v[4:7], v[68:71], v[148:151], v[4:7]
    ds_read_b128 v[184:187], v38 offset:640
    s_waitcnt lgkmcnt(8)
    v_mfma_f32_16x16x32_bf16 v[4:7], v[72:75], v[152:155], v[4:7]
    ds_read_b128 v[188:191], v38 offset:704
    s_waitcnt lgkmcnt(8)
    v_mfma_f32_16x16x32_bf16 v[4:7], v[76:79], v[156:159], v[4:7]
    ds_read_b128 v[192:195], v38 offset:768
    s_waitcnt lgkmcnt(8)
    v_mfma_f32_16x16x32_bf16 v[4:7], v[80:83], v[160:163], v[4:7]
    ds_read_b128 v[196:199], v38 offset:832
    s_waitcnt lgkmcnt(8)
    v_mfma_f32_16x16x32_bf16 v[4:7], v[84:87], v[164:167], v[4:7]
    ds_read_b128 v[200:203], v38 offset:896
    s_waitcnt lgkmcnt(8)
    v_mfma_f32_16x16x32_bf16 v[4:7], v[88:91], v[168:171], v[4:7]
    ds_read_b128 v[204:207], v38 offset:960
    s_waitcnt lgkmcnt(8)
    v_mfma_f32_16x16x32_bf16 v[4:7], v[92:95], v[172:175], v[4:7]
    s_waitcnt lgkmcnt(7)
    v_mfma_f32_16x16x32_bf16 v[4:7], v[96:99], v[176:179], v[4:7]
    s_waitcnt lgkmcnt(6)
    v_mfma_f32_16x16x32_bf16 v[4:7], v[100:103], v[180:183], v[4:7]
    s_waitcnt lgkmcnt(5)
    v_mfma_f32_16x16x32_bf16 v[4:7], v[104:107], v[184:187], v[4:7]
    s_waitcnt lgkmcnt(4)
    v_mfma_f32_16x16x32_bf16 v[4:7], v[108:111], v[188:191], v[4:7]
    s_waitcnt lgkmcnt(3)
    v_mfma_f32_16x16x32_bf16 v[4:7], v[112:115], v[192:195], v[4:7]
    s_waitcnt lgkmcnt(2)
    v_mfma_f32_16x16x32_bf16 v[4:7], v[116:119], v[196:199], v[4:7]
    s_waitcnt lgkmcnt(1)
    v_mfma_f32_16x16x32_bf16 v[4:7], v[120:123], v[200:203], v[4:7]
    s_waitcnt lgkmcnt(0)
    v_mfma_f32_16x16x32_bf16 v[4:7], v[124:127], v[204:207], v[4:7]
    s_nop 7
    v_cvt_pk_bf16_f32 v12, v4, v5
    v_lshlrev_b32 v4, 16, v12
    v_and_b32 v5, 0xffff0000, v12
    v_cvt_pk_bf16_f32 v13, v6, v7
    v_lshlrev_b32 v6, 16, v13
    v_and_b32 v7, 0xffff0000, v13
    v_mov_b32 v8, v4
    v_mov_b32 v9, v5
    v_mov_b32 v10, v6
    v_mov_b32 v11, v7
    v_permlane32_swap_b32 v4, v8
    v_permlane32_swap_b32 v5, v9
    v_permlane32_swap_b32 v6, v10
    v_permlane32_swap_b32 v7, v11
    v_max_f32 v4, 0, v4
    v_max_f32 v5, 0, v5
    v_max_f32 v6, 0, v6
    v_max_f32 v7, 0, v7
    v_pk_mul_f32 v[4:5], v[4:5], v[8:9]
    v_pk_mul_f32 v[6:7], v[6:7], v[10:11]
    v_cvt_pk_bf16_f32 v8, v4, v5
    v_cvt_pk_bf16_f32 v9, v6, v7
    s_mov_b32 exec_lo, 0x000f000f
    s_mov_b32 exec_hi, 0
    ds_write_b64 v46, v[8:9]
    s_mov_b64 exec, -1
Lmg_29:
    s_waitcnt lgkmcnt(0)
    s_barrier
    ds_read_b128 v[16:19], v39
    s_waitcnt lgkmcnt(0)
    v_mfma_f32_16x16x32_bf16 v[4:7], v[128:131], v[16:19], 0
    v_mfma_f32_16x16x32_bf16 v[8:11], v[132:135], v[16:19], 0
    v_mfma_f32_16x16x32_bf16 v[12:15], v[136:139], v[16:19], 0
    v_mfma_f32_16x16x32_bf16 v[20:23], v[140:143], v[16:19], 0
    s_nop 5
    v_mov_b32_dpp v4, v8 quad_perm:[0,1,2,3] row_mask:0xf bank_mask:0x2
    v_mov_b32_dpp v5, v9 quad_perm:[0,1,2,3] row_mask:0xf bank_mask:0x2
    v_mov_b32_dpp v6, v10 quad_perm:[0,1,2,3] row_mask:0xf bank_mask:0x2
    v_mov_b32_dpp v7, v11 quad_perm:[0,1,2,3] row_mask:0xf bank_mask:0x2
    v_mov_b32_dpp v4, v12 quad_perm:[0,1,2,3] row_mask:0xf bank_mask:0x4
    v_mov_b32_dpp v5, v13 quad_perm:[0,1,2,3] row_mask:0xf bank_mask:0x4
    v_mov_b32_dpp v6, v14 quad_perm:[0,1,2,3] row_mask:0xf bank_mask:0x4
    v_mov_b32_dpp v7, v15 quad_perm:[0,1,2,3] row_mask:0xf bank_mask:0x4
    v_mov_b32_dpp v4, v20 quad_perm:[0,1,2,3] row_mask:0xf bank_mask:0x8
    v_mov_b32_dpp v5, v21 quad_perm:[0,1,2,3] row_mask:0xf bank_mask:0x8
    v_mov_b32_dpp v6, v22 quad_perm:[0,1,2,3] row_mask:0xf bank_mask:0x8
    v_mov_b32_dpp v7, v23 quad_perm:[0,1,2,3] row_mask:0xf bank_mask:0x8
    v_bfi_b32 v4, s91, v48, v4
    v_bfi_b32 v5, s91, v49, v5
    v_bfi_b32 v6, s91, v50, v6
    v_bfi_b32 v7, s91, v51, v7
    buffer_store_dwordx4 v[4:7], v47, s[40:43], s63 offen sc0 sc1
    s_endpgm
L_ROLE_GA:
    s_mov_b32 s48, s22
    s_mov_b32 s49, s23
    s_mov_b32 s50, 4096
    s_mov_b32 s51, 0x20000
    v_lshrrev_b32 v1, 4, v0
    v_lshlrev_b32 v1, 1, v1
    v_and_b32 v2, 7, v0
    v_xor_b32 v1, v1, v2
    v_lshlrev_b32 v1, 4, v1
    v_lshrrev_b32 v2, 3, v0
    v_mul_u32_u24 v2, 6144, v2
    v_add_u32 v32, v1, v2
    s_lshl_b32 s59, s34, 6
    s_mul_i32 s59, s59, 6144
    s_lshl_b32 s61, s32, 7
    s_add_u32 s59, s59, s61
    s_add_u32 s59, s59, 2048
    s_lshl_b32 s61, s34, 13
    s_add_u32 s61, s61, 32768
    s_mov_b32 m0, s61
    s_barrier
    s_cmp_lt_u32 s34, 4
    s_cbranch_scc0 Lgc_30
    s_lshl_b32 s61, s34, 10
    v_lshlrev_b32 v1, 3, v0
    buffer_load_dwordx2 v[24:25], v1, s[48:51], s61 offen
    buffer_load_dwordx2 v[26:27], v1, s[48:51], s61 offen offset:512
Lgc_30:
    s_mov_b32 s38, 8
Ldma_31:
    buffer_load_dwordx4 v32, s[44:47], s59 offen lds
    s_add_u32 s59, s59, 49152
    s_add_u32 m0, m0, 1024
    s_sub_u32 s38, s38, 1
    s_cmp_lg_u32 s38, 0
    s_cbranch_scc1 Ldma_31
    s_cmp_lt_u32 s34, 4
    s_cbranch_scc0 Lgc2_32
    s_waitcnt vmcnt(8)
    v_lshrrev_b32 v5, 3, v0
    v_lshlrev_b32 v5, 6, v5
    v_and_b32 v6, 3, v0
    v_lshl_add_u32 v5, v6, 4, v5
    v_bfe_u32 v6, v0, 2, 1
    v_lshl_add_u32 v5, v6, 3, v5
    s_mul_i32 s61, s34, 1056
    s_add_u32 s61, s61, 131072
    v_add_u32 v5, s61, v5
    v_lshlrev_b32 v8, 16, v24
    v_and_b32 v9, 0xffff0000, v24
    v_lshlrev_b32 v10, 16, v25
    v_and_b32 v11, 0xffff0000, v25
    s_mov_b32 s94, 0xbfb8aa3b
    s_mov_b32 s95, 0xb2a57060
    v_mul_f32 v12, 0xbfb8aa3b, v8
    v_fma_f32 v16, v8, s94, -v12
    v_fma_f32 v16, v8, s95, v16
    v_exp_f32 v12, v12
    v_mul_f32 v16, 0x3f317218, v16
    v_add_f32 v16, 1.0, v16
    v_mul_f32 v12, v12, v16
    v_add_f32 v12, 1.0, v12
    v_rcp_f32 v16, v12
    v_cmp_eq_f32 vcc, 0x7f800000, v12
    v_mul_f32 v20, v8, v16
    v_fma_f32 v21, -v20, v12, v8
    v_fma_f32 v21, v21, v16, v20
    v_cndmask_b32 v8, v21, v20, vcc
    v_mul_f32 v13, 0xbfb8aa3b, v9
    v_fma_f32 v17, v9, s94, -v13
    v_fma_f32 v17, v9, s95, v17
    v_exp_f32 v13, v13
    v_mul_f32 v17, 0x3f317218, v17
    v_add_f32 v17, 1.0, v17
    v_mul_f32 v13, v13, v17
    v_add_f32 v13, 1.0, v13
    v_rcp_f32 v17, v13
    v_cmp_eq_f32 vcc, 0x7f800000, v13
    v_mul_f32 v20, v9, v17
    v_fma_f32 v21, -v20, v13, v9
    v_fma_f32 v21, v21, v17, v20
    v_cndmask_b32 v9, v21, v20, vcc
    v_mul_f32 v14, 0xbfb8aa3b, v10
    v_fma_f32 v18, v10, s94, -v14
    v_fma_f32 v18, v10, s95, v18
    v_exp_f32 v14, v14
    v_mul_f32 v18, 0x3f317218, v18
    v_add_f32 v18, 1.0, v18
    v_mul_f32 v14, v14, v18
    v_add_f32 v14, 1.0, v14
    v_rcp_f32 v18, v14
    v_cmp_eq_f32 vcc, 0x7f800000, v14
    v_mul_f32 v20, v10, v18
    v_fma_f32 v21, -v20, v14, v10
    v_fma_f32 v21, v21, v18, v20
    v_cndmask_b32 v10, v21, v20, vcc
    v_mul_f32 v15, 0xbfb8aa3b, v11
    v_fma_f32 v19, v11, s94, -v15
    v_fma_f32 v19, v11, s95, v19
    v_exp_f32 v15, v15
    v_mul_f32 v19, 0x3f317218, v19
    v_add_f32 v19, 1.0, v19
    v_mul_f32 v15, v15, v19
    v_add_f32 v15, 1.0, v15
    v_rcp_f32 v19, v15
    v_cmp_eq_f32 vcc, 0x7f800000, v15
    v_mul_f32 v20, v11, v19
    v_fma_f32 v21, -v20, v15, v11
    v_fma_f32 v21, v21, v19, v20
    v_cndmask_b32 v11, v21, v20, vcc
    v_cvt_pk_bf16_f32 v8, v8, v9
    v_cvt_pk_bf16_f32 v9, v10, v11
    ds_write_b64 v5, v[8:9] offset:0
    v_lshlrev_b32 v8, 16, v26
    v_and_b32 v9, 0xffff0000, v26
    v_lshlrev_b32 v10, 16, v27
    v_and_b32 v11, 0xffff0000, v27
    s_mov_b32 s94, 0xbfb8aa3b
    s_mov_b32 s95, 0xb2a57060
    v_mul_f32 v12, 0xbfb8aa3b, v8
    v_fma_f32 v16, v8, s94, -v12
    v_fma_f32 v16, v8, s95, v16
    v_exp_f32 v12, v12
    v_mul_f32 v16, 0x3f317218, v16
    v_add_f32 v16, 1.0, v16
    v_mul_f32 v12, v12, v16
    v_add_f32 v12, 1.0, v12
    v_rcp_f32 v16, v12
    v_cmp_eq_f32 vcc, 0x7f800000, v12
    v_mul_f32 v20, v8, v16
    v_fma_f32 v21, -v20, v12, v8
    v_fma_f32 v21, v21, v16, v20
    v_cndmask_b32 v8, v21, v20, vcc
    v_mul_f32 v13, 0xbfb8aa3b, v9
    v_fma_f32 v17, v9, s94, -v13
    v_fma_f32 v17, v9, s95, v17
    v_exp_f32 v13, v13
    v_mul_f32 v17, 0x3f317218, v17
    v_add_f32 v17, 1.0, v17
    v_mul_f32 v13, v13, v17
    v_add_f32 v13, 1.0, v13
    v_rcp_f32 v17, v13
    v_cmp_eq_f32 vcc, 0x7f800000, v13
    v_mul_f32 v20, v9, v17
    v_fma_f32 v21, -v20, v13, v9
    v_fma_f32 v21, v21, v17, v20
    v_cndmask_b32 v9, v21, v20, vcc
    v_mul_f32 v14, 0xbfb8aa3b, v10
    v_fma_f32 v18, v10, s94, -v14
    v_fma_f32 v18, v10, s95, v18
    v_exp_f32 v14, v14
    v_mul_f32 v18, 0x3f317218, v18
    v_add_f32 v18, 1.0, v18
    v_mul_f32 v14, v14, v18
    v_add_f32 v14, 1.0, v14
    v_rcp_f32 v18, v14
    v_cmp_eq_f32 vcc, 0x7f800000, v14
    v_mul_f32 v20, v10, v18
    v_fma_f32 v21, -v20, v14, v10
    v_fma_f32 v21, v21, v18, v20
    v_cndmask_b32 v10, v21, v20, vcc
    v_mul_f32 v15, 0xbfb8aa3b, v11
    v_fma_f32 v19, v11, s94, -v15
    v_fma_f32 v19, v11, s95, v19
    v_exp_f32 v15, v15
    v_mul_f32 v19, 0x3f317218, v19
    v_add_f32 v19, 1.0, v19
    v_mul_f32 v15, v15, v19
    v_add_f32 v15, 1.0, v15
    v_rcp_f32 v19, v15
    v_cmp_eq_f32 vcc, 0x7f800000, v15
    v_mul_f32 v20, v11, v19
    v_fma_f32 v21, -v20, v15, v11
    v_fma_f32 v21, v21, v19, v20
    v_cndmask_b32 v11, v21, v20, vcc
    v_cvt_pk_bf16_f32 v8, v8, v9
    v_cvt_pk_bf16_f32 v9, v10, v11
    ds_write_b64 v5, v[8:9] offset:512
Lgc2_32:
    s_lshl_b32 s61, s34, 5
    v_lshrrev_b32 v1, 4, v0
    v_lshlrev_b32 v33, 9, v1
    v_and_b32 v1, 1, v1
    v_lshlrev_b32 v1, 6, v1
    v_bfe_u32 v2, v0, 2, 2
    v_lshl_add_u32 v33, v2, 7, v33
    v_lshrrev_b32 v2, 1, v2
    v_lshl_or_b32 v1, v2, 5, v1
    v_xor_b32 v1, s61, v1
    v_add_u32 v33, v33, v1
    v_and_b32 v2, 3, v0
    v_lshl_add_u32 v33, v2, 3, v33
    v_add_u32 v33, 32768, v33
    v_and_b32 v1, 3, v0
    v_mul_u32_u24 v35, 1056, v1
    v_lshrrev_b32 v1, 4, v0
    v_lshl_add_u32 v35, v1, 4, v35
    v_add_u32 v35, 131072, v35
    v_lshrrev_b32 v1, 5, v0
    v_lshlrev_b32 v36, 10, v1
    v_bfe_u32 v1, v0, 2, 1
    v_lshl_add_u32 v36, v1, 7, v36
    v_and_b32 v1, 3, v0
    v_lshl_add_u32 v36, v1, 5, v36
    v_bfe_u32 v1, v0, 4, 1
    v_lshl_add_u32 v36, v1, 4, v36
    s_lshl_b32 s59, s32, 13
    s_lshl_b32 s61, s34, 11
    s_add_u32 s59, s59, s61
    s_add_u32 s59, s59, 995328
    s_mov_b32 s92, 0x0c0c0400
    s_mov_b32 s93, 0x04000c0c
    s_movk_i32 s91, 0xff
    v_mov_b32 v28, s35
    v_lshrrev_b32 v29, 8, v28
    v_lshrrev_b32 v30, 16, v28
    v_lshrrev_b32 v31, 24, v28
    s_waitcnt vmcnt(0) lgkmcnt(0)
    s_barrier
    s_cmp_lt_u32 s34, 4
    s_cbranch_scc0 Lge_33
    ds_read_b64_tr_b16 v[64:65], v33 offset:0
    ds_read_b64_tr_b16 v[66:67], v33 offset:2048
    ds_read_b64_tr_b16 v[68:69], v33 offset:4096
    ds_read_b64_tr_b16 v[70:71], v33 offset:6144
    ds_read_b64_tr_b16 v[72:73], v33 offset:8192
    ds_read_b64_tr_b16 v[74:75], v33 offset:10240
    ds_read_b64_tr_b16 v[76:77], v33 offset:12288
    ds_read_b64_tr_b16 v[78:79], v33 offset:14336
    ds_read_b64_tr_b16 v[80:81], v33 offset:16384
    ds_read_b64_tr_b16 v[82:83], v33 offset:18432
    ds_read_b64_tr_b16 v[84:85], v33 offset:20480
    ds_read_b64_tr_b16 v[86:87], v33 offset:22528
    ds_read_b64_tr_b16 v[88:89], v33 offset:24576
    ds_read_b64_tr_b16 v[90:91], v33 offset:26624
    s_waitcnt lgkmcnt(0)
    ds_read_b64_tr_b16 v[92:93], v33 offset:28672
    ds_read_b64_tr_b16 v[94:95], v33 offset:30720
    ds_read_b64_tr_b16 v[96:97], v33 offset:32768
    ds_read_b64_tr_b16 v[98:99], v33 offset:34816
    ds_read_b64_tr_b16 v[100:101], v33 offset:36864
    ds_read_b64_tr_b16 v[102:103], v33 offset:38912
    ds_read_b64_tr_b16 v[104:105], v33 offset:40960
    ds_read_b64_tr_b16 v[106:107], v33 offset:43008
    ds_read_b64_tr_b16 v[108:109], v33 offset:45056
    ds_read_b64_tr_b16 v[110:111], v33 offset:47104
    ds_read_b64_tr_b16 v[112:113], v33 offset:49152
    ds_read_b64_tr_b16 v[114:115], v33 offset:51200
    ds_read_b64_tr_b16 v[116:117], v33 offset:53248
    ds_read_b64_tr_b16 v[118:119], v33 offset:55296
    s_waitcnt lgkmcnt(0)
    ds_read_b64_tr_b16 v[120:121], v33 offset:57344
    ds_read_b64_tr_b16 v[122:123], v33 offset:59392
    ds_read_b64_tr_b16 v[124:125], v33 offset:61440
    ds_read_b64_tr_b16 v[126:127], v33 offset:63488
    s_waitcnt lgkmcnt(0)
    ds_read_b128 v[144:147], v35 offset:0
    ds_read_b128 v[148:151], v35 offset:64
    ds_read_b128 v[152:155], v35 offset:128
    ds_read_b128 v[156:159], v35 offset:192
    ds_read_b128 v[160:163], v35 offset:256
    ds_read_b128 v[164:167], v35 offset:320
    ds_read_b128 v[168:171], v35 offset:384
    ds_read_b128 v[172:175], v35 offset:448
    ds_read_b128 v[176:179], v35 offset:512
    s_waitcnt lgkmcnt(8)
    v_mfma_f32_16x16x32_bf16 v[4:7], v[64:67], v[144:147], 0
    ds_read_b128 v[180:183], v35 offset:576
    s_waitcnt lgkmcnt(8)
    v_mfma_f32_16x16x32_bf16 v[4:7], v[68:71], v[148:151], v[4:7]
    ds_read_b128 v[184:187], v35 offset:640
    s_waitcnt lgkmcnt(8)
    v_mfma_f32_16x16x32_bf16 v[4:7], v[72:75], v[152:155], v[4:7]
    ds_read_b128 v[188:191], v35 offset:704
    s_waitcnt lgkmcnt(8)
    v_mfma_f32_16x16x32_bf16 v[4:7], v[76:79], v[156:159], v[4:7]
    ds_read_b128 v[192:195], v35 offset:768
    s_waitcnt lgkmcnt(8)
    v_mfma_f32_16x16x32_bf16 v[4:7], v[80:83], v[160:163], v[4:7]
    ds_read_b128 v[196:199], v35 offset:832
    s_waitcnt lgkmcnt(8)
    v_mfma_f32_16x16x32_bf16 v[4:7], v[84:87], v[164:167], v[4:7]
    ds_read_b128 v[200:203], v35 offset:896
    s_waitcnt lgkmcnt(8)
    v_mfma_f32_16x16x32_bf16 v[4:7], v[88:91], v[168:171], v[4:7]
    ds_read_b128 v[204:207], v35 offset:960
    s_waitcnt lgkmcnt(8)
    v_mfma_f32_16x16x32_bf16 v[4:7], v[92:95], v[172:175], v[4:7]
    s_waitcnt lgkmcnt(7)
    v_mfma_f32_16x16x32_bf16 v[4:7], v[96:99], v[176:179], v[4:7]
    s_waitcnt lgkmcnt(6)
    v_mfma_f32_16x16x32_bf16 v[4:7], v[100:103], v[180:183], v[4:7]
    s_waitcnt lgkmcnt(5)
    v_mfma_f32_16x16x32_bf16 v[4:7], v[104:107], v[184:187], v[4:7]
    s_waitcnt lgkmcnt(4)
    v_mfma_f32_16x16x32_bf16 v[4:7], v[108:111], v[188:191], v[4:7]
    s_waitcnt lgkmcnt(3)
    v_mfma_f32_16x16x32_bf16 v[4:7], v[112:115], v[192:195], v[4:7]
    s_waitcnt lgkmcnt(2)
    v_mfma_f32_16x16x32_bf16 v[4:7], v[116:119], v[196:199], v[4:7]
    s_waitcnt lgkmcnt(1)
    v_mfma_f32_16x16x32_bf16 v[4:7], v[120:123], v[200:203], v[4:7]
    s_waitcnt lgkmcnt(0)
    v_mfma_f32_16x16x32_bf16 v[4:7], v[124:127], v[204:207], v[4:7]
    s_mov_b32 exec_lo, 0x00f000f0
    s_mov_b32 exec_hi, 0x00f000f0
    s_nop 5
    v_mov_b32 v4, 0
    v_mov_b32 v5, 0
    v_mov_b32 v6, 0
    v_mov_b32 v7, 0
    s_mov_b32 exec_lo, 0x00ff00ff
    s_mov_b32 exec_hi, 0x00ff00ff
    v_bfi_b32 v4, s91, v28, v4
    v_bfi_b32 v5, s91, v29, v5
    v_bfi_b32 v6, s91, v30, v6
    v_bfi_b32 v7, s91, v31, v7
    buffer_store_dwordx4 v[4:7], v36, s[40:43], s59 offen sc0 sc1
    s_mov_b64 exec, -1
Lge_33:
    s_endpgm
L_ROLE_W:
    s_mov_b32 s40, s30
    s_mov_b32 s41, s31
    s_mov_b32 s42, 4194304
    s_mov_b32 s43, 0x20000
    s_lshl_b32 s61, s34, 6
    v_add_u32 v1, s61, v0
    v_lshlrev_b32 v33, 4, v1
    v_lshrrev_b32 v2, 3, v1
    v_lshlrev_b32 v2, 1, v2
    v_and_b32 v3, 1, v1
    v_add_u32 v2, v2, v3
    v_lshrrev_b32 v34, 3, v2
    v_lshlrev_b32 v34, 6, v34
    v_and_b32 v3, 3, v2
    v_lshl_add_u32 v34, v3, 4, v34
    v_bfe_u32 v3, v2, 2, 1
    v_lshl_add_u32 v34, v3, 3, v34
    v_bfe_u32 v3, v1, 1, 2
    v_mul_u32_u24 v3, 1056, v3
    v_add_u32 v34, v34, v3
    v_add_u32 v34, 131072, v34
    v_bfe_u32 v2, v1, 4, 2
    v_lshlrev_b32 v2, 5, v2
    v_bfe_u32 v3, v1, 6, 1
    v_lshl_add_u32 v2, v3, 4, v2
    v_and_b32 v3, 15, v1
    v_add_u32 v2, v2, v3
    v_lshrrev_b32 v35, 3, v2
    v_lshlrev_b32 v35, 6, v35
    v_and_b32 v3, 3, v2
    v_lshl_add_u32 v35, v3, 4, v35
    v_bfe_u32 v3, v2, 2, 1
    v_lshl_add_u32 v35, v3, 3, v35
    v_lshrrev_b32 v3, 7, v1
    v_mul_u32_u24 v3, 1056, v3
    v_add_u32 v35, v35, v3
    v_add_u32 v35, 135296, v35
    s_and_b32 s61, s34, 3
    s_lshl_b32 s61, s61, 5
    v_lshrrev_b32 v1, 4, v0
    v_lshlrev_b32 v36, 9, v1
    v_and_b32 v1, 1, v1
    v_lshlrev_b32 v1, 6, v1
    v_bfe_u32 v2, v0, 2, 2
    v_lshl_add_u32 v36, v2, 7, v36
    v_lshrrev_b32 v2, 1, v2
    v_lshl_or_b32 v1, v2, 5, v1
    v_xor_b32 v1, s61, v1
    v_add_u32 v36, v36, v1
    v_and_b32 v2, 3, v0
    v_lshl_add_u32 v36, v2, 3, v36
    v_add_u32 v36, 0, v36
    v_add_u32 v37, 65536, v36
    v_and_b32 v1, 3, v0
    v_mul_u32_u24 v38, 1056, v1
    v_lshrrev_b32 v1, 4, v0
    v_lshl_add_u32 v38, v1, 4, v38
    v_add_u32 v38, 131072, v38
    v_add_u32 v39, 4224, v38
    v_and_b32 v1, 3, v0
    v_lshlrev_b32 v40, 6, v1
    v_lshrrev_b32 v1, 4, v0
    v_lshl_add_u32 v40, v1, 4, v40
    s_lshl_b32 s57, s32, 3
    s_add_u32 s57, s57, s56
    s_lshl_b32 s57, s57, 2
    s_add_u32 s57, s57, s34
    s_lshl_b32 s57, s57, 8
    s_add_u32 s57, s57, 274432
    s_mov_b32 s58, 266240
    s_xor_b32 s56, s56, 4
    s_mov_b32 s52, s4
    s_mov_b32 s53, s5
    s_mov_b32 s54, 4096
    s_mov_b32 s55, 0x20000
    v_bfe_u32 v1, v0, 1, 2
    v_lshlrev_b32 v1, 10, v1
    v_and_b32 v2, 1, v0
    v_lshl_add_u32 v1, v2, 3, v1
    v_lshrrev_b32 v2, 4, v0
    v_lshl_add_u32 v1, v2, 1, v1
    s_lshl_b32 s61, s56, 7
    s_lshl_b32 s62, s34, 4
    s_add_u32 s61, s61, s62
    buffer_load_ushort v60, v1, s[52:55], s61 offen
    s_mov_b32 s44, s12
    s_mov_b32 s45, s13
    s_mov_b32 s46, 4194304
    s_mov_b32 s47, 0x20000
    v_lshrrev_b32 v1, 4, v0
    v_lshlrev_b32 v1, 1, v1
    v_and_b32 v2, 7, v0
    v_xor_b32 v1, v1, v2
    v_lshlrev_b32 v1, 4, v1
    v_lshrrev_b32 v2, 3, v0
    v_mul_u32_u24 v2, 1024, v2
    v_add_u32 v32, v1, v2
    s_lshl_b32 s59, s32, 9
    s_lshl_b32 s61, s34, 6
    s_add_u32 s59, s59, s61
    s_lshl_b32 s59, s59, 10
    s_lshl_b32 s61, s56, 7
    s_add_u32 s59, s59, s61
    s_lshl_b32 s67, s34, 13
    s_add_u32 s67, s67, 65536
    s_mov_b32 s89, 8
    s_cmp_eq_u32 s56, 3
    s_cbranch_scc0 Lwo3_34
    s_mov_b32 m0, s67
    s_mov_b32 s38, 2
Ldma_35:
    buffer_load_dwordx4 v32, s[44:47], s59 offen lds
    s_add_u32 s59, s59, 8192
    s_add_u32 m0, m0, 1024
    s_sub_u32 s38, s38, 1
    s_cmp_lg_u32 s38, 0
    s_cbranch_scc1 Ldma_35
    s_add_u32 s67, s67, 2048
    s_mov_b32 s89, 6
Lwo3_34:
    s_waitcnt lgkmcnt(0)
    s_add_u32 s35, s36, 2654435769
    s_cmp_eq_u32 s34, 0
    s_cbranch_scc0 Lxp_36
    s_getreg_b32 s39, hwreg(HW_REG_XCC_ID, 0, 4)
    s_add_u32 s39, s39, s36
    s_add_u32 s39, s39, 2654435769
    v_mov_b32 v209, s39
    s_lshl_b32 s39, s32, 5
    s_add_u32 s39, s39, s33
    s_lshl_b32 s39, s39, 2
    v_mov_b32 v208, s39
    s_mov_b64 exec, 1
    buffer_store_dword v209, v208, s[40:43], 0 offen offset:2048 sc0 sc1
    s_mov_b64 exec, -1
Lxp_36:
    buffer_load_dwordx4 v[4:7], v33, s[40:43], s58 offen sc1
    s_waitcnt vmcnt(0)
    v_and_b32 v211, 31, v0
    v_lshlrev_b32 v211, 2, v211
    s_lshl_b32 s90, s32, 7
    buffer_load_dword v210, v211, s[40:43], s90 offen offset:2048 sc1
    s_barrier
    s_cmp_lt_u32 s34, 4
    s_cbranch_scc0 Lw1_37
    ds_read_b64_tr_b16 v[64:65], v36 offset:0
    ds_read_b64_tr_b16 v[66:67], v36 offset:2048
    ds_read_b64_tr_b16 v[68:69], v36 offset:4096
    ds_read_b64_tr_b16 v[70:71], v36 offset:6144
    ds_read_b64_tr_b16 v[72:73], v36 offset:8192
    ds_read_b64_tr_b16 v[74:75], v36 offset:10240
    ds_read_b64_tr_b16 v[76:77], v36 offset:12288
    ds_read_b64_tr_b16 v[78:79], v36 offset:14336
    ds_read_b64_tr_b16 v[80:81], v36 offset:16384
    ds_read_b64_tr_b16 v[82:83], v36 offset:18432
    ds_read_b64_tr_b16 v[84:85], v36 offset:20480
    ds_read_b64_tr_b16 v[86:87], v36 offset:22528
    ds_read_b64_tr_b16 v[88:89], v36 offset:24576
    ds_read_b64_tr_b16 v[90:91], v36 offset:26624
    s_waitcnt lgkmcnt(6)
    ds_read_b64_tr_b16 v[92:93], v36 offset:28672
    ds_read_b64_tr_b16 v[94:95], v36 offset:30720
    ds_read_b64_tr_b16 v[96:97], v36 offset:32768
    ds_read_b64_tr_b16 v[98:99], v36 offset:34816
    ds_read_b64_tr_b16 v[100:101], v36 offset:36864
    ds_read_b64_tr_b16 v[102:103], v36 offset:38912
    ds_read_b64_tr_b16 v[104:105], v36 offset:40960
    ds_read_b64_tr_b16 v[106:107], v36 offset:43008
    s_waitcnt lgkmcnt(6)
    ds_read_b64_tr_b16 v[108:109], v36 offset:45056
    ds_read_b64_tr_b16 v[110:111], v36 offset:47104
    ds_read_b64_tr_b16 v[112:113], v36 offset:49152
    ds_read_b64_tr_b16 v[114:115], v36 offset:51200
    ds_read_b64_tr_b16 v[116:117], v36 offset:53248
    ds_read_b64_tr_b16 v[118:119], v36 offset:55296
    ds_read_b64_tr_b16 v[120:121], v36 offset:57344
    ds_read_b64_tr_b16 v[122:123], v36 offset:59392
    ds_read_b64_tr_b16 v[124:125], v36 offset:61440
    ds_read_b64_tr_b16 v[126:127], v36 offset:63488
Lw1_37:
    v_cmp_ne_u32 vcc, s35, v6
    s_cbranch_vccz LA2ok_38
    s_mov_b32 s37, 100000
LA2_39:
    buffer_load_dwordx4 v[4:7], v33, s[40:43], s58 offen sc1
    s_waitcnt vmcnt(0)
    v_cmp_ne_u32 vcc, s35, v6
    s_cbranch_vccz LA2ok_38
    s_sub_u32 s37, s37, 1
    s_cbranch_scc0 LA2_39
LA2ok_38:
    ds_write_b64 v34, v[4:5]
    s_waitcnt lgkmcnt(0)
    s_barrier
    s_mov_b32 m0, s67
    s_cmp_lt_u32 s34, 4
    s_cbranch_scc0 Lwqskip_40
    ds_read_b128 v[128:131], v38 offset:0
    ds_read_b128 v[132:135], v38 offset:64
    ds_read_b128 v[136:139], v38 offset:128
    ds_read_b128 v[140:143], v38 offset:192
    ds_read_b128 v[144:147], v38 offset:256
    ds_read_b128 v[148:151], v38 offset:320
    ds_read_b128 v[152:155], v38 offset:384
    ds_read_b128 v[156:159], v38 offset:448
    ds_read_b128 v[160:163], v38 offset:512
    s_waitcnt lgkmcnt(8)
    v_mfma_f32_16x16x32_bf16 v[4:7], v[64:67], v[128:131], 0
    ds_read_b128 v[164:167], v38 offset:576
    s_waitcnt lgkmcnt(8)
    v_mfma_f32_16x16x32_bf16 v[4:7], v[68:71], v[132:135], v[4:7]
    ds_read_b128 v[168:171], v38 offset:640
    s_waitcnt lgkmcnt(8)
    v_mfma_f32_16x16x32_bf16 v[4:7], v[72:75], v[136:139], v[4:7]
    ds_read_b128 v[172:175], v38 offset:704
    s_waitcnt lgkmcnt(8)
    v_mfma_f32_16x16x32_bf16 v[4:7], v[76:79], v[140:143], v[4:7]
    ds_read_b128 v[176:179], v38 offset:768
    s_waitcnt lgkmcnt(8)
    v_mfma_f32_16x16x32_bf16 v[4:7], v[80:83], v[144:147], v[4:7]
    ds_read_b128 v[180:183], v38 offset:832
    s_waitcnt lgkmcnt(8)
    v_mfma_f32_16x16x32_bf16 v[4:7], v[84:87], v[148:151], v[4:7]
    ds_read_b128 v[184:187], v38 offset:896
    s_waitcnt lgkmcnt(8)
    v_mfma_f32_16x16x32_bf16 v[4:7], v[88:91], v[152:155], v[4:7]
    ds_read_b128 v[188:191], v38 offset:960
    s_waitcnt lgkmcnt(8)
    v_mfma_f32_16x16x32_bf16 v[4:7], v[92:95], v[156:159], v[4:7]
    s_waitcnt lgkmcnt(7)
    v_mfma_f32_16x16x32_bf16 v[4:7], v[96:99], v[160:163], v[4:7]
    s_waitcnt lgkmcnt(6)
    v_mfma_f32_16x16x32_bf16 v[4:7], v[100:103], v[164:167], v[4:7]
    s_waitcnt lgkmcnt(5)
    v_mfma_f32_16x16x32_bf16 v[4:7], v[104:107], v[168:171], v[4:7]
    s_waitcnt lgkmcnt(4)
    v_mfma_f32_16x16x32_bf16 v[4:7], v[108:111], v[172:175], v[4:7]
    s_waitcnt lgkmcnt(3)
    v_mfma_f32_16x16x32_bf16 v[4:7], v[112:115], v[176:179], v[4:7]
    s_waitcnt lgkmcnt(2)
    v_mfma_f32_16x16x32_bf16 v[4:7], v[116:119], v[180:183], v[4:7]
    s_waitcnt lgkmcnt(1)
    v_mfma_f32_16x16x32_bf16 v[4:7], v[120:123], v[184:187], v[4:7]
    s_waitcnt lgkmcnt(0)
    v_mfma_f32_16x16x32_bf16 v[4:7], v[124:127], v[188:191], v[4:7]
    s_nop 7
    v_cvt_pk_bf16_f32 v8, v4, v5
    v_cvt_pk_bf16_f32 v9, v6, v7
    v_mov_b32 v10, s35
    v_mov_b32 v11, 0
    s_mov_b32 exec_lo, 0x000f000f
    s_mov_b32 exec_hi, 0x000f000f
    s_or_b32 s39, s57, 2097152
    buffer_store_dwordx4 v[8:11], v40, s[40:43], s39 offen
    s_mov_b64 exec, -1
Lwqskip_40:
    s_barrier
    s_waitcnt vmcnt(1)
    s_getreg_b32 s39, hwreg(HW_REG_XCC_ID, 0, 4)
    s_add_u32 s39, s39, s35
    v_cmp_ne_u32 vcc, s39, v210
    s_nop 0
    s_cmp_eq_u64 vcc, 0
    s_cselect_b32 s90, 1, 0
    s_cmp_lt_u32 s34, 4
    s_cbranch_scc0 Lwq3_41
    s_mov_b32 exec_lo, 0x000f000f
    s_mov_b32 exec_hi, 0x000f000f
    s_cmp_eq_u32 s90, 1
    s_cbranch_scc1 Lsg_42
    buffer_store_dwordx4 v[8:11], v40, s[40:43], s57 offen sc0 sc1
Lsg_42:
    s_mov_b64 exec, -1
Lwq3_41:
    s_mov_b32 s38, s89
Ldma_43:
    buffer_load_dwordx4 v32, s[44:47], s59 offen lds
    s_add_u32 s59, s59, 8192
    s_add_u32 m0, m0, 1024
    s_sub_u32 s38, s38, 1
    s_cmp_lg_u32 s38, 0
    s_cbranch_scc1 Ldma_43
    s_lshl_b32 s58, s32, 13
    s_add_u32 s58, s58, 864256
    v_lshrrev_b32 v1, 5, v0
    v_lshlrev_b32 v41, 10, v1
    v_and_b32 v1, 3, v0
    v_lshl_add_u32 v41, v1, 5, v41
    v_bfe_u32 v1, v0, 4, 1
    v_lshl_add_u32 v41, v1, 4, v41
    s_lshl_b32 s57, s56, 13
    s_and_b32 s61, s34, 3
    s_lshl_b32 s61, s61, 11
    s_add_u32 s57, s57, s61
    s_lshr_b32 s61, s34, 2
    s_lshl_b32 s61, s61, 10
    s_add_u32 s57, s57, s61
    s_lshl_b32 s61, s32, 7
    s_add_u32 s57, s57, s61
    s_add_u32 s57, s57, 929792
    v_lshlrev_b32 v42, 4, v0
    s_lshl_b32 s62, s56, 3
    s_add_u32 s62, s62, s34
    s_lshl_b32 s63, s62, 10
    s_add_u32 s63, s63, 995328
    s_lshl_b32 s62, s62, 10
    s_add_u32 s62, s62, 929792
    v_bfe_u32 v1, v0, 1, 2
    v_lshlrev_b32 v43, 12, v1
    v_and_b32 v1, 1, v0
    v_lshl_add_u32 v43, v1, 4, v43
    s_lshl_b32 s66, s32, 14
    s_lshl_b32 s61, s56, 8
    s_add_u32 s66, s66, s61
    s_lshl_b32 s61, s34, 5
    s_add_u32 s66, s66, s61
    s_add_u32 s66, s66, 1060864
    v_bfe_u32 v1, v0, 1, 2
    v_lshlrev_b32 v61, 10, v1
    v_and_b32 v2, 1, v0
    v_lshl_add_u32 v61, v2, 3, v61
    v_lshrrev_b32 v2, 4, v0
    v_lshl_add_u32 v61, v2, 1, v61
    s_lshl_b32 s68, s56, 7
    s_lshl_b32 s61, s32, 4
    s_add_u32 s68, s68, s61
    s_lshl_b32 s69, s56, 3
    s_add_u32 s69, s69, s32
    s_mul_i32 s69, s69, 7168
    s_add_u32 s69, s69, 1191936
    buffer_load_dwordx4 v[4:7], v42, s[40:43], s62 offen sc1
    buffer_load_dwordx4 v[8:11], v42, s[40:43], s63 offen sc1
    s_cmp_eq_u32 s34, s32
    s_cbranch_scc0 Lwt1_44
    s_add_u32 s61, s69, 4096
    buffer_load_dwordx4 v[64:67], v42, s[40:43], s69 offen sc1
    buffer_load_dwordx4 v[68:71], v42, s[40:43], s69 offen offset:1024 sc1
    buffer_load_dwordx4 v[72:75], v42, s[40:43], s69 offen offset:2048 sc1
    buffer_load_dwordx4 v[76:79], v42, s[40:43], s69 offen offset:3072 sc1
    buffer_load_dwordx4 v[80:83], v42, s[40:43], s61 offen sc1
    buffer_load_dwordx4 v[84:87], v42, s[40:43], s61 offen offset:1024 sc1
    buffer_load_dwordx4 v[88:91], v42, s[40:43], s61 offen offset:2048 sc1
Lwt1_44:
    s_mov_b32 s48, s26
    s_mov_b32 s49, s27
    s_mov_b32 s50, 4096
    s_mov_b32 s51, 0x20000
    s_mov_b32 s92, 0x0c0c0400
    s_mov_b32 s93, 0x04000c0c
    s_movk_i32 s91, 0xff
    v_mov_b32 v48, s35
    v_lshrrev_b32 v49, 8, v48
    v_lshrrev_b32 v50, 16, v48
    v_lshrrev_b32 v51, 24, v48
    v_lshlrev_b32 v60, 16, v60
    s_or_b32 s58, s58, 2097152
    buffer_load_dwordx4 v[4:7], v33, s[40:43], s58 offen sc1
    s_waitcnt vmcnt(0)
    s_barrier
    s_cmp_lt_u32 s34, 4
    s_cbranch_scc0 Lw2_45
    ds_read_b64_tr_b16 v[64:65], v37 offset:0
    ds_read_b64_tr_b16 v[66:67], v37 offset:2048
    ds_read_b64_tr_b16 v[68:69], v37 offset:4096
    ds_read_b64_tr_b16 v[70:71], v37 offset:6144
    ds_read_b64_tr_b16 v[72:73], v37 offset:8192
    ds_read_b64_tr_b16 v[74:75], v37 offset:10240
    ds_read_b64_tr_b16 v[76:77], v37 offset:12288
    ds_read_b64_tr_b16 v[78:79], v37 offset:14336
    ds_read_b64_tr_b16 v[80:81], v37 offset:16384
    ds_read_b64_tr_b16 v[82:83], v37 offset:18432
    ds_read_b64_tr_b16 v[84:85], v37 offset:20480
    ds_read_b64_tr_b16 v[86:87], v37 offset:22528
    ds_read_b64_tr_b16 v[88:89], v37 offset:24576
    ds_read_b64_tr_b16 v[90:91], v37 offset:26624
    s_waitcnt lgkmcnt(6)
    ds_read_b64_tr_b16 v[92:93], v37 offset:28672
    ds_read_b64_tr_b16 v[94:95], v37 offset:30720
    ds_read_b64_tr_b16 v[96:97], v37 offset:32768
    ds_read_b64_tr_b16 v[98:99], v37 offset:34816
    ds_read_b64_tr_b16 v[100:101], v37 offset:36864
    ds_read_b64_tr_b16 v[102:103], v37 offset:38912
    ds_read_b64_tr_b16 v[104:105], v37 offset:40960
    ds_read_b64_tr_b16 v[106:107], v37 offset:43008
    s_waitcnt lgkmcnt(6)
    ds_read_b64_tr_b16 v[108:109], v37 offset:45056
    ds_read_b64_tr_b16 v[110:111], v37 offset:47104
    ds_read_b64_tr_b16 v[112:113], v37 offset:49152
    ds_read_b64_tr_b16 v[114:115], v37 offset:51200
    ds_read_b64_tr_b16 v[116:117], v37 offset:53248
    ds_read_b64_tr_b16 v[118:119], v37 offset:55296
    ds_read_b64_tr_b16 v[120:121], v37 offset:57344
    ds_read_b64_tr_b16 v[122:123], v37 offset:59392
    ds_read_b64_tr_b16 v[124:125], v37 offset:61440
    ds_read_b64_tr_b16 v[126:127], v37 offset:63488
Lw2_45:
    v_cmp_ne_u32 vcc, s35, v6
    s_cbranch_vccz LCok_46
    s_mov_b32 s37, 100000
LC_47:
    buffer_load_dwordx4 v[4:7], v33, s[40:43], s58 offen sc1
    s_waitcnt vmcnt(0)
    v_cmp_ne_u32 vcc, s35, v6
    s_cbranch_vccz LCok_46
    s_cmp_lt_u32 s37, 99800
    s_cselect_b32 s39, 2097152, 0
    s_xor_b32 s58, s58, s39
    s_sub_u32 s37, s37, 1
    s_cbranch_scc0 LC_47
LCok_46:
    ds_write_b64 v35, v[4:5]
    s_waitcnt lgkmcnt(0)
    s_barrier
    s_cmp_lt_u32 s34, 4
    s_cbranch_scc0 Lwo_48
    ds_read_b128 v[128:131], v39 offset:0
    ds_read_b128 v[132:135], v39 offset:64
    ds_read_b128 v[136:139], v39 offset:128
    ds_read_b128 v[140:143], v39 offset:192
    ds_read_b128 v[144:147], v39 offset:256
    ds_read_b128 v[148:151], v39 offset:320
    ds_read_b128 v[152:155], v39 offset:384
    ds_read_b128 v[156:159], v39 offset:448
    ds_read_b128 v[160:163], v39 offset:512
    s_waitcnt lgkmcnt(8)
    v_mfma_f32_16x16x32_bf16 v[4:7], v[64:67], v[128:131], 0
    ds_read_b128 v[164:167], v39 offset:576
    s_waitcnt lgkmcnt(8)
    v_mfma_f32_16x16x32_bf16 v[4:7], v[68:71], v[132:135], v[4:7]
    ds_read_b128 v[168:171], v39 offset:640
    s_waitcnt lgkmcnt(8)
    v_mfma_f32_16x16x32_bf16 v[4:7], v[72:75], v[136:139], v[4:7]
    ds_read_b128 v[172:175], v39 offset:704
    s_waitcnt lgkmcnt(8)
    v_mfma_f32_16x16x32_bf16 v[4:7], v[76:79], v[140:143], v[4:7]
    ds_read_b128 v[176:179], v39 offset:768
    s_waitcnt lgkmcnt(8)
    v_mfma_f32_16x16x32_bf16 v[4:7], v[80:83], v[144:147], v[4:7]
    ds_read_b128 v[180:183], v39 offset:832
    s_waitcnt lgkmcnt(8)
    v_mfma_f32_16x16x32_bf16 v[4:7], v[84:87], v[148:151], v[4:7]
    ds_read_b128 v[184:187], v39 offset:896
    s_waitcnt lgkmcnt(8)
    v_mfma_f32_16x16x32_bf16 v[4:7], v[88:91], v[152:155], v[4:7]
    ds_read_b128 v[188:191], v39 offset:960
    s_waitcnt lgkmcnt(8)
    v_mfma_f32_16x16x32_bf16 v[4:7], v[92:95], v[156:159], v[4:7]
    s_waitcnt lgkmcnt(7)
    v_mfma_f32_16x16x32_bf16 v[4:7], v[96:99], v[160:163], v[4:7]
    s_waitcnt lgkmcnt(6)
    v_mfma_f32_16x16x32_bf16 v[4:7], v[100:103], v[164:167], v[4:7]
    s_waitcnt lgkmcnt(5)
    v_mfma_f32_16x16x32_bf16 v[4:7], v[104:107], v[168:171], v[4:7]
    s_waitcnt lgkmcnt(4)
    v_mfma_f32_16x16x32_bf16 v[4:7], v[108:111], v[172:175], v[4:7]
    s_waitcnt lgkmcnt(3)
    v_mfma_f32_16x16x32_bf16 v[4:7], v[112:115], v[176:179], v[4:7]
    s_waitcnt lgkmcnt(2)
    v_mfma_f32_16x16x32_bf16 v[4:7], v[116:119], v[180:183], v[4:7]
    s_waitcnt lgkmcnt(1)
    v_mfma_f32_16x16x32_bf16 v[4:7], v[120:123], v[184:187], v[4:7]
    s_waitcnt lgkmcnt(0)
    v_mfma_f32_16x16x32_bf16 v[4:7], v[124:127], v[188:191], v[4:7]
    s_nop 7
    v_bfi_b32 v4, s91, v48, v4
    v_bfi_b32 v5, s91, v49, v5
    v_bfi_b32 v6, s91, v50, v6
    v_bfi_b32 v7, s91, v51, v7
    s_mov_b32 exec_lo, 0x000f000f
    s_mov_b32 exec_hi, 0x000f000f
    buffer_store_dwordx4 v[4:7], v41, s[40:43], s57 offen sc0 sc1
    s_mov_b64 exec, -1
Lwo_48:
    s_mov_b32 s37, 100000
LML_50:
    buffer_load_dwordx4 v[4:7], v42, s[40:43], s63 offen sc1
    s_waitcnt vmcnt(0)
    v_perm_b32 v12, v5, v4, s92
    v_perm_b32 v13, v7, v6, s93
    v_or_b32 v12, v12, v13
    v_cmp_ne_u32 vcc, s35, v12
    s_cbranch_vccz LMLok_49
    s_sub_u32 s37, s37, 1
    s_cbranch_scc0 LML_50
LMLok_49:
    buffer_load_dwordx4 v[24:27], v42, s[40:43], s62 offen sc1
    v_and_b32 v4, 0xffffff00, v4
    v_and_b32 v5, 0xffffff00, v5
    v_and_b32 v6, 0xffffff00, v6
    v_and_b32 v7, 0xffffff00, v7
    v_add_f32_dpp v4, v4, v4 row_ror:8 row_mask:0xf bank_mask:0xf
    v_add_f32_dpp v5, v5, v5 row_ror:8 row_mask:0xf bank_mask:0xf
    v_add_f32_dpp v6, v6, v6 row_ror:8 row_mask:0xf bank_mask:0xf
    v_add_f32_dpp v7, v7, v7 row_ror:8 row_mask:0xf bank_mask:0xf
    v_cvt_pk_bf16_f32 v12, v4, v5
    v_lshlrev_b32 v4, 16, v12
    v_and_b32 v5, 0xffff0000, v12
    v_cvt_pk_bf16_f32 v13, v6, v7
    v_lshlrev_b32 v6, 16, v13
    v_and_b32 v7, 0xffff0000, v13
    s_mov_b32 exec_lo, 0
    s_mov_b32 exec_hi, 0x0000ffff
    v_add_f32 v4, 1.0, v4
    v_add_f32 v5, 1.0, v5
    v_add_f32 v6, 1.0, v6
    v_add_f32 v7, 1.0, v7
    v_cvt_pk_bf16_f32 v12, v4, v5
    v_lshlrev_b32 v4, 16, v12
    v_and_b32 v5, 0xffff0000, v12
    v_cvt_pk_bf16_f32 v13, v6, v7
    v_lshlrev_b32 v6, 16, v13
    v_and_b32 v7, 0xffff0000, v13
    s_mov_b64 exec, -1
    v_cvt_pk_bf16_f32 v8, v4, v5
    v_cvt_pk_bf16_f32 v9, v6, v7
    v_mov_b32 v16, 0
    v_mov_b32 v17, 0
    v_mov_b32 v18, 0
    v_mov_b32 v19, 0
    v_mov_b32 v10, v8
    v_mov_b32 v11, v9
    v_mov_b32 v14, v8
    v_mov_b32 v15, v9
    v_permlane32_swap_b32 v10, v16
    v_permlane32_swap_b32 v11, v17
    v_permlane16_swap_b32 v14, v18
    v_permlane16_swap_b32 v15, v19
    v_mov_b32 v58, v16
    v_mov_b32 v20, v17
    v_mov_b32 v21, v18
    v_mov_b32 v22, v19
    v_mov_b32 v23, s35
    s_mov_b64 exec, 0xff
    s_or_b32 s39, s66, 2097152
    buffer_store_dwordx4 v[20:23], v43, s[40:43], s39 offen offset:2048
    s_cmp_eq_u32 s90, 1
    s_cbranch_scc1 Lsg_51
    buffer_store_dwordx4 v[20:23], v43, s[40:43], s66 offen offset:2048 sc0 sc1
Lsg_51:
    s_mov_b64 exec, -1
    v_permlane16_swap_b32 v4, v5
    v_permlane16_swap_b32 v6, v7
    s_nop 1
    v_permlane32_swap_b32 v4, v6
    v_permlane32_swap_b32 v5, v7
    v_mov_b32 v56, v4
    v_mov_b32 v57, v7
    s_waitcnt vmcnt(1)
    v_perm_b32 v12, v25, v24, s92
    v_perm_b32 v13, v27, v26, s93
    v_or_b32 v12, v12, v13
    v_cmp_ne_u32 vcc, s35, v12
    s_cbranch_vccz Lc2first_52
    s_mov_b32 s37, 100000
LC2_55:
    buffer_load_dwordx4 v[4:7], v42, s[40:43], s62 offen sc1
    s_waitcnt vmcnt(0)
    v_perm_b32 v12, v5, v4, s92
    v_perm_b32 v13, v7, v6, s93
    v_or_b32 v12, v12, v13
    v_cmp_ne_u32 vcc, s35, v12
    s_cbranch_vccz LC2ok_54
    s_sub_u32 s37, s37, 1
    s_cbranch_scc0 LC2_55
LC2ok_54:
    s_branch Lc2got_53
Lc2first_52:
    v_mov_b32 v4, v24
    v_mov_b32 v5, v25
    v_mov_b32 v6, v26
    v_mov_b32 v7, v27
Lc2got_53:
    v_and_b32 v4, 0xffffff00, v4
    v_and_b32 v5, 0xffffff00, v5
    v_and_b32 v6, 0xffffff00, v6
    v_and_b32 v7, 0xffffff00, v7
    v_add_f32_dpp v4, v4, v4 row_ror:8 row_mask:0xf bank_mask:0xf
    v_add_f32_dpp v5, v5, v5 row_ror:8 row_mask:0xf bank_mask:0xf
    v_add_f32_dpp v6, v6, v6 row_ror:8 row_mask:0xf bank_mask:0xf
    v_add_f32_dpp v7, v7, v7 row_ror:8 row_mask:0xf bank_mask:0xf
    v_permlane16_swap_b32 v4, v5
    s_nop 0
    v_permlane16_swap_b32 v6, v7
    v_add_f32 v4, v4, v5
    v_add_f32 v6, v6, v7
    s_nop 1
    v_permlane32_swap_b32 v4, v6
    v_add_f32 v4, v4, v6
    v_cvt_pk_bf16_f32 v4, v4, v4
    v_and_b32 v4, 0xffff0000, v4
    v_mul_f32 v4, v56, v4
    v_cvt_pk_bf16_f32 v4, v4, v4
    v_and_b32 v4, 0xffff0000, v4
    v_add_f32 v4, v60, v4
    v_cvt_pk_bf16_f32 v59, v4, v4
    v_and_b32 v59, 0xffff0000, v59
    v_mov_b32 v10, v58
    v_mov_b32 v11, s35
    v_mov_b32 v8, v59
    v_mov_b32 v12, v59
    s_nop 1
    v_permlane16_swap_b32 v8, v12
    v_cvt_pk_bf16_f32 v8, v8, v12
    v_mov_b32 v9, v8
    s_nop 1
    v_permlane32_swap_b32 v8, v9
    s_mov_b64 exec, 0xff
    s_or_b32 s39, s66, 2097152
    buffer_store_dwordx4 v[8:11], v43, s[40:43], s39 offen
    s_barrier
    s_cmp_eq_u32 s90, 1
    s_cbranch_scc1 Lsg_56
    buffer_store_dwordx4 v[8:11], v43, s[40:43], s66 offen sc0 sc1
Lsg_56:
    s_mov_b64 exec, -1
    s_cmp_eq_u32 s34, s32
    s_cbranch_scc0 Lwend_57
    s_add_u32 s61, s69, 4096
    buffer_load_dwordx4 v[64:67], v42, s[40:43], s69 offen sc1
    buffer_load_dwordx4 v[68:71], v42, s[40:43], s69 offen offset:1024 sc1
    buffer_load_dwordx4 v[72:75], v42, s[40:43], s69 offen offset:2048 sc1
    buffer_load_dwordx4 v[76:79], v42, s[40:43], s69 offen offset:3072 sc1
    buffer_load_dwordx4 v[80:83], v42, s[40:43], s61 offen sc1
    buffer_load_dwordx4 v[84:87], v42, s[40:43], s61 offen offset:1024 sc1
    buffer_load_dwordx4 v[88:91], v42, s[40:43], s61 offen offset:2048 sc1
    s_sleep 1
    buffer_load_dwordx4 v[92:95], v42, s[40:43], s69 offen sc1
    buffer_load_dwordx4 v[96:99], v42, s[40:43], s69 offen offset:1024 sc1
    buffer_load_dwordx4 v[100:103], v42, s[40:43], s69 offen offset:2048 sc1
    buffer_load_dwordx4 v[104:107], v42, s[40:43], s69 offen offset:3072 sc1
    buffer_load_dwordx4 v[108:111], v42, s[40:43], s61 offen sc1
    buffer_load_dwordx4 v[112:115], v42, s[40:43], s61 offen offset:1024 sc1
    buffer_load_dwordx4 v[116:119], v42, s[40:43], s61 offen offset:2048 sc1
    s_sleep 1
    s_mov_b32 s37, 33333
LE_62:
    buffer_load_dwordx4 v[120:123], v42, s[40:43], s69 offen sc1
    buffer_load_dwordx4 v[124:127], v42, s[40:43], s69 offen offset:1024 sc1
    buffer_load_dwordx4 v[128:131], v42, s[40:43], s69 offen offset:2048 sc1
    buffer_load_dwordx4 v[132:135], v42, s[40:43], s69 offen offset:3072 sc1
    buffer_load_dwordx4 v[136:139], v42, s[40:43], s61 offen sc1
    buffer_load_dwordx4 v[140:143], v42, s[40:43], s61 offen offset:1024 sc1
    buffer_load_dwordx4 v[144:147], v42, s[40:43], s61 offen offset:2048 sc1
    s_waitcnt vmcnt(14)
    v_perm_b32 v12, v65, v64, s92
    v_perm_b32 v20, v67, v66, s93
    v_or_b32 v12, v12, v20
    v_perm_b32 v13, v69, v68, s92
    v_perm_b32 v20, v71, v70, s93
    v_or_b32 v13, v13, v20
    v_perm_b32 v14, v73, v72, s92
    v_perm_b32 v20, v75, v74, s93
    v_or_b32 v14, v14, v20
    v_perm_b32 v15, v77, v76, s92
    v_perm_b32 v20, v79, v78, s93
    v_or_b32 v15, v15, v20
    v_perm_b32 v16, v81, v80, s92
    v_perm_b32 v20, v83, v82, s93
    v_or_b32 v16, v16, v20
    v_perm_b32 v17, v85, v84, s92
    v_perm_b32 v20, v87, v86, s93
    v_or_b32 v17, v17, v20
    v_perm_b32 v18, v89, v88, s92
    v_perm_b32 v20, v91, v90, s93
    v_or_b32 v18, v18, v20
    v_cmp_ne_u32 vcc, s35, v12
    v_cmp_ne_u32 s[64:65], s35, v13
    s_nop 0
    s_or_b64 vcc, vcc, s[64:65]
    v_cmp_ne_u32 s[64:65], s35, v14
    s_nop 0
    s_or_b64 vcc, vcc, s[64:65]
    v_cmp_ne_u32 s[64:65], s35, v15
    s_nop 0
    s_or_b64 vcc, vcc, s[64:65]
    v_cmp_ne_u32 s[64:65], s35, v16
    s_nop 0
    s_or_b64 vcc, vcc, s[64:65]
    v_cmp_ne_u32 s[64:65], s35, v17
    s_nop 0
    s_or_b64 vcc, vcc, s[64:65]
    v_cmp_ne_u32 s[64:65], s35, v18
    s_nop 0
    s_or_b64 vcc, vcc, s[64:65]
    s_cbranch_scc0 LEok0__58
    s_sleep 1
    buffer_load_dwordx4 v[64:67], v42, s[40:43], s69 offen sc1
    buffer_load_dwordx4 v[68:71], v42, s[40:43], s69 offen offset:1024 sc1
    buffer_load_dwordx4 v[72:75], v42, s[40:43], s69 offen offset:2048 sc1
    buffer_load_dwordx4 v[76:79], v42, s[40:43], s69 offen offset:3072 sc1
    buffer_load_dwordx4 v[80:83], v42, s[40:43], s61 offen sc1
    buffer_load_dwordx4 v[84:87], v42, s[40:43], s61 offen offset:1024 sc1
    buffer_load_dwordx4 v[88:91], v42, s[40:43], s61 offen offset:2048 sc1
    s_waitcnt vmcnt(14)
    v_perm_b32 v12, v93, v92, s92
    v_perm_b32 v20, v95, v94, s93
    v_or_b32 v12, v12, v20
    v_perm_b32 v13, v97, v96, s92
    v_perm_b32 v20, v99, v98, s93
    v_or_b32 v13, v13, v20
    v_perm_b32 v14, v101, v100, s92
    v_perm_b32 v20, v103, v102, s93
    v_or_b32 v14, v14, v20
    v_perm_b32 v15, v105, v104, s92
    v_perm_b32 v20, v107, v106, s93
    v_or_b32 v15, v15, v20
    v_perm_b32 v16, v109, v108, s92
    v_perm_b32 v20, v111, v110, s93
    v_or_b32 v16, v16, v20
    v_perm_b32 v17, v113, v112, s92
    v_perm_b32 v20, v115, v114, s93
    v_or_b32 v17, v17, v20
    v_perm_b32 v18, v117, v116, s92
    v_perm_b32 v20, v119, v118, s93
    v_or_b32 v18, v18, v20
    v_cmp_ne_u32 vcc, s35, v12
    v_cmp_ne_u32 s[64:65], s35, v13
    s_nop 0
    s_or_b64 vcc, vcc, s[64:65]
    v_cmp_ne_u32 s[64:65], s35, v14
    s_nop 0
    s_or_b64 vcc, vcc, s[64:65]
    v_cmp_ne_u32 s[64:65], s35, v15
    s_nop 0
    s_or_b64 vcc, vcc, s[64:65]
    v_cmp_ne_u32 s[64:65], s35, v16
    s_nop 0
    s_or_b64 vcc, vcc, s[64:65]
    v_cmp_ne_u32 s[64:65], s35, v17
    s_nop 0
    s_or_b64 vcc, vcc, s[64:65]
    v_cmp_ne_u32 s[64:65], s35, v18
    s_nop 0
    s_or_b64 vcc, vcc, s[64:65]
    s_cbranch_scc0 LEok1__59
    s_sleep 1
    buffer_load_dwordx4 v[92:95], v42, s[40:43], s69 offen sc1
    buffer_load_dwordx4 v[96:99], v42, s[40:43], s69 offen offset:1024 sc1
    buffer_load_dwordx4 v[100:103], v42, s[40:43], s69 offen offset:2048 sc1
    buffer_load_dwordx4 v[104:107], v42, s[40:43], s69 offen offset:3072 sc1
    buffer_load_dwordx4 v[108:111], v42, s[40:43], s61 offen sc1
    buffer_load_dwordx4 v[112:115], v42, s[40:43], s61 offen offset:1024 sc1
    buffer_load_dwordx4 v[116:119], v42, s[40:43], s61 offen offset:2048 sc1
    s_waitcnt vmcnt(14)
    v_perm_b32 v12, v121, v120, s92
    v_perm_b32 v20, v123, v122, s93
    v_or_b32 v12, v12, v20
    v_perm_b32 v13, v125, v124, s92
    v_perm_b32 v20, v127, v126, s93
    v_or_b32 v13, v13, v20
    v_perm_b32 v14, v129, v128, s92
    v_perm_b32 v20, v131, v130, s93
    v_or_b32 v14, v14, v20
    v_perm_b32 v15, v133, v132, s92
    v_perm_b32 v20, v135, v134, s93
    v_or_b32 v15, v15, v20
    v_perm_b32 v16, v137, v136, s92
    v_perm_b32 v20, v139, v138, s93
    v_or_b32 v16, v16, v20
    v_perm_b32 v17, v141, v140, s92
    v_perm_b32 v20, v143, v142, s93
    v_or_b32 v17, v17, v20
    v_perm_b32 v18, v145, v144, s92
    v_perm_b32 v20, v147, v146, s93
    v_or_b32 v18, v18, v20
    v_cmp_ne_u32 vcc, s35, v12
    v_cmp_ne_u32 s[64:65], s35, v13
    s_nop 0
    s_or_b64 vcc, vcc, s[64:65]
    v_cmp_ne_u32 s[64:65], s35, v14
    s_nop 0
    s_or_b64 vcc, vcc, s[64:65]
    v_cmp_ne_u32 s[64:65], s35, v15
    s_nop 0
    s_or_b64 vcc, vcc, s[64:65]
    v_cmp_ne_u32 s[64:65], s35, v16
    s_nop 0
    s_or_b64 vcc, vcc, s[64:65]
    v_cmp_ne_u32 s[64:65], s35, v17
    s_nop 0
    s_or_b64 vcc, vcc, s[64:65]
    v_cmp_ne_u32 s[64:65], s35, v18
    s_nop 0
    s_or_b64 vcc, vcc, s[64:65]
    s_cbranch_scc0 LEok2__60
    s_sleep 1
    s_sub_u32 s37, s37, 1
    s_cbranch_scc0 LE_62
    s_branch LEok0__58
LEok2__60:
    v_and_b32 v160, 0xffffff00, v120
    v_and_b32 v161, 0xffffff00, v121
    v_and_b32 v162, 0xffffff00, v122
    v_and_b32 v163, 0xffffff00, v123
    v_and_b32 v164, 0xffffff00, v124
    v_and_b32 v165, 0xffffff00, v125
    v_and_b32 v166, 0xffffff00, v126
    v_and_b32 v167, 0xffffff00, v127
    v_and_b32 v168, 0xffffff00, v128
    v_and_b32 v169, 0xffffff00, v129
    v_and_b32 v170, 0xffffff00, v130
    v_and_b32 v171, 0xffffff00, v131
    v_and_b32 v172, 0xffffff00, v132
    v_and_b32 v173, 0xffffff00, v133
    v_and_b32 v174, 0xffffff00, v134
    v_and_b32 v175, 0xffffff00, v135
    v_and_b32 v176, 0xffffff00, v136
    v_and_b32 v177, 0xffffff00, v137
    v_and_b32 v178, 0xffffff00, v138
    v_and_b32 v179, 0xffffff00, v139
    v_and_b32 v180, 0xffffff00, v140
    v_and_b32 v181, 0xffffff00, v141
    v_and_b32 v182, 0xffffff00, v142
    v_and_b32 v183, 0xffffff00, v143
    v_and_b32 v184, 0xffffff00, v144
    v_and_b32 v185, 0xffffff00, v145
    v_and_b32 v186, 0xffffff00, v146
    v_and_b32 v187, 0xffffff00, v147
    s_branch LEdone_61
LEok1__59:
    v_and_b32 v160, 0xffffff00, v92
    v_and_b32 v161, 0xffffff00, v93
    v_and_b32 v162, 0xffffff00, v94
    v_and_b32 v163, 0xffffff00, v95
    v_and_b32 v164, 0xffffff00, v96
    v_and_b32 v165, 0xffffff00, v97
    v_and_b32 v166, 0xffffff00, v98
    v_and_b32 v167, 0xffffff00, v99
    v_and_b32 v168, 0xffffff00, v100
    v_and_b32 v169, 0xffffff00, v101
    v_and_b32 v170, 0xffffff00, v102
    v_and_b32 v171, 0xffffff00, v103
    v_and_b32 v172, 0xffffff00, v104
    v_and_b32 v173, 0xffffff00, v105
    v_and_b32 v174, 0xffffff00, v106
    v_and_b32 v175, 0xffffff00, v107
    v_and_b32 v176, 0xffffff00, v108
    v_and_b32 v177, 0xffffff00, v109
    v_and_b32 v178, 0xffffff00, v110
    v_and_b32 v179, 0xffffff00, v111
    v_and_b32 v180, 0xffffff00, v112
    v_and_b32 v181, 0xffffff00, v113
    v_and_b32 v182, 0xffffff00, v114
    v_and_b32 v183, 0xffffff00, v115
    v_and_b32 v184, 0xffffff00, v116
    v_and_b32 v185, 0xffffff00, v117
    v_and_b32 v186, 0xffffff00, v118
    v_and_b32 v187, 0xffffff00, v119
    s_branch LEdone_61
LEok0__58:
    v_and_b32 v160, 0xffffff00, v64
    v_and_b32 v161, 0xffffff00, v65
    v_and_b32 v162, 0xffffff00, v66
    v_and_b32 v163, 0xffffff00, v67
    v_and_b32 v164, 0xffffff00, v68
    v_and_b32 v165, 0xffffff00, v69
    v_and_b32 v166, 0xffffff00, v70
    v_and_b32 v167, 0xffffff00, v71
    v_and_b32 v168, 0xffffff00, v72
    v_and_b32 v169, 0xffffff00, v73
    v_and_b32 v170, 0xffffff00, v74
    v_and_b32 v171, 0xffffff00, v75
    v_and_b32 v172, 0xffffff00, v76
    v_and_b32 v173, 0xffffff00, v77
    v_and_b32 v174, 0xffffff00, v78
    v_and_b32 v175, 0xffffff00, v79
    v_and_b32 v176, 0xffffff00, v80
    v_and_b32 v177, 0xffffff00, v81
    v_and_b32 v178, 0xffffff00, v82
    v_and_b32 v179, 0xffffff00, v83
    v_and_b32 v180, 0xffffff00, v84
    v_and_b32 v181, 0xffffff00, v85
    v_and_b32 v182, 0xffffff00, v86
    v_and_b32 v183, 0xffffff00, v87
    v_and_b32 v184, 0xffffff00, v88
    v_and_b32 v185, 0xffffff00, v89
    v_and_b32 v186, 0xffffff00, v90
    v_and_b32 v187, 0xffffff00, v91
LEdone_61:
    v_pk_add_f32 v[160:161], v[160:161], v[164:165]
    v_pk_add_f32 v[162:163], v[162:163], v[166:167]
    v_pk_add_f32 v[168:169], v[168:169], v[172:173]
    v_pk_add_f32 v[170:171], v[170:171], v[174:175]
    v_pk_add_f32 v[176:177], v[176:177], v[180:181]
    v_pk_add_f32 v[178:179], v[178:179], v[182:183]
    v_pk_add_f32 v[160:161], v[160:161], v[168:169]
    v_pk_add_f32 v[162:163], v[162:163], v[170:171]
    v_pk_add_f32 v[176:177], v[176:177], v[184:185]
    v_pk_add_f32 v[178:179], v[178:179], v[186:187]
    v_pk_add_f32 v[160:161], v[160:161], v[176:177]
    v_pk_add_f32 v[162:163], v[162:163], v[178:179]
    s_nop 0
    v_add_f32_dpp v160, v160, v160 row_ror:8 row_mask:0xf bank_mask:0xf
    v_add_f32_dpp v161, v161, v161 row_ror:8 row_mask:0xf bank_mask:0xf
    v_add_f32_dpp v162, v162, v162 row_ror:8 row_mask:0xf bank_mask:0xf
    v_add_f32_dpp v163, v163, v163 row_ror:8 row_mask:0xf bank_mask:0xf
    v_permlane16_swap_b32 v160, v161
    s_nop 0
    v_permlane16_swap_b32 v162, v163
    v_add_f32 v160, v160, v161
    v_add_f32 v162, v162, v163
    s_nop 1
    v_permlane32_swap_b32 v160, v162
    v_add_f32 v160, v160, v162
    v_cvt_pk_bf16_f32 v160, v160, v160
    v_and_b32 v160, 0xffff0000, v160
    v_mul_f32 v160, v57, v160
    v_cvt_pk_bf16_f32 v160, v160, v160
    v_and_b32 v160, 0xffff0000, v160
    v_add_f32 v160, v59, v160
    v_cvt_pk_bf16_f32 v160, v160, v160
    s_mov_b32 exec_lo, 0x00ff00ff
    s_mov_b32 exec_hi, 0x00ff00ff
    buffer_store_short v160, v61, s[48:51], s68 offen
    s_mov_b64 exec, -1
    s_cmp_eq_u32 s2, 64
    s_cbranch_scc0 Lnoep_63
    v_mov_b32 v1, 0
    v_mov_b32 v2, s35
    s_mov_b64 exec, 1
    buffer_store_dword v2, v1, s[40:43], 0 offen offset:0
    s_mov_b64 exec, -1
Lnoep_63:
Lwend_57:
    s_endpgm
L_ROLE_K:
    s_mov_b32 s40, s30
    s_mov_b32 s41, s31
    s_mov_b32 s42, 4194304
    s_mov_b32 s43, 0x20000
    s_lshl_b32 s66, s32, 3
    s_add_u32 s66, s66, s56
    s_and_b32 s67, s66, 1
    v_lshrrev_b32 v1, 4, v0
    v_and_b32 v2, 15, v0
    v_and_b32 v4, 3, v2
    v_xor_b32 v4, v4, v1
    v_and_b32 v5, 12, v2
    v_lshlrev_b32 v6, 8, v2
    v_add_u32 v6, s62, v6
    v_xor_b32 v3, 0, v5
    v_add_u32 v3, v3, v4
    v_lshl_add_u32 v36, v3, 4, v6
    v_xor_b32 v3, 4, v5
    v_add_u32 v3, v3, v4
    v_lshl_add_u32 v37, v3, 4, v6
    v_xor_b32 v3, 8, v5
    v_add_u32 v3, v3, v4
    v_lshl_add_u32 v38, v3, 4, v6
    v_xor_b32 v3, 12, v5
    v_add_u32 v3, v3, v4
    v_lshl_add_u32 v39, v3, 4, v6
    s_lshl_b32 s61, s34, 6
    v_add_u32 v5, s61, v0
    v_lshrrev_b32 v6, 2, v5
    v_lshlrev_b32 v6, 8, v6
    v_and_b32 v7, 3, v5
    v_lshl_add_u32 v40, v7, 4, v6
    v_lshrrev_b32 v6, 5, v5
    v_mul_u32_u24 v6, 288, v6
    v_and_b32 v7, 31, v5
    v_lshl_add_u32 v6, v7, 3, v6
    v_add_u32 v41, 131072, v6
    s_lshl_b32 s69, s32, 13
    s_lshl_b32 s61, s57, 6
    s_add_u32 s69, s69, s61
    s_add_u32 s69, s69, 274432
    v_and_b32 v5, 3, v0
    v_mul_u32_u24 v42, 288, v5
    v_lshrrev_b32 v5, 4, v0
    v_lshl_add_u32 v42, v5, 4, v42
    v_add_u32 v42, 131072, v42
    v_bfe_u32 v5, v0, 2, 2
    v_lshl_add_u32 v5, v5, 2, v1
    v_lshlrev_b32 v5, 6, v5
    v_and_b32 v6, 3, v0
    v_lshl_add_u32 v43, v6, 4, v5
    s_lshl_b32 s63, s60, 14
    s_add_u32 s63, s63, 339968
    s_lshl_b32 s61, s58, 13
    s_add_u32 s63, s63, s61
    s_lshl_b32 s61, s34, 10
    s_add_u32 s63, s63, s61
    s_lshr_b32 s68, s66, 4
    s_add_u32 s68, s68, 1
    s_lshr_b32 s56, s66, 1
    s_and_b32 s56, s56, 7
    s_mov_b32 s48, s24
    s_mov_b32 s49, s25
    s_mov_b32 s50, 3145728
    s_mov_b32 s51, 0x20000
    v_lshrrev_b32 v1, 4, v0
    v_lshlrev_b32 v1, 1, v1
    v_and_b32 v2, 7, v0
    v_xor_b32 v1, v1, v2
    v_lshlrev_b32 v1, 4, v1
    v_lshrrev_b32 v2, 3, v0
    v_mul_u32_u24 v2, 6144, v2
    v_add_u32 v32, v1, v2
    s_lshl_b32 s59, s67, 8
    s_lshl_b32 s61, s34, 5
    s_add_u32 s59, s59, s61
    s_mul_i32 s59, s59, 6144
    s_lshl_b32 s61, s68, 10
    s_add_u32 s59, s59, s61
    s_lshl_b32 s61, s56, 7
    s_add_u32 s59, s59, s61
    s_add_u32 s59, s59, 2048
    s_waitcnt lgkmcnt(0)
    s_add_u32 s35, s36, 2654435769
    v_and_b32 v211, 31, v0
    v_lshlrev_b32 v211, 2, v211
    s_lshl_b32 s90, s32, 7
    buffer_load_dword v210, v211, s[40:43], s90 offen offset:2048 sc1
    s_cmp_lt_u32 s34, 2
    s_cbranch_scc0 Lknp_64
    s_or_b32 s69, s69, 2097152
    buffer_load_dwordx4 v[4:7], v40, s[40:43], s69 offen sc1
    s_waitcnt vmcnt(0)
    s_getreg_b32 s39, hwreg(HW_REG_XCC_ID, 0, 4)
    s_add_u32 s39, s39, s35
    v_cmp_ne_u32 vcc, s39, v210
    s_nop 0
    s_cmp_eq_u64 vcc, 0
    s_cselect_b32 s90, 1, 0
    ds_read_b128 v[64:67], v36 offset:0
    ds_read_b128 v[68:71], v37 offset:0
    ds_read_b128 v[72:75], v38 offset:0
    ds_read_b128 v[76:79], v39 offset:0
    ds_read_b128 v[80:83], v36 offset:4096
    ds_read_b128 v[84:87], v37 offset:4096
    ds_read_b128 v[88:91], v38 offset:4096
    ds_read_b128 v[92:95], v39 offset:4096
    ds_read_b128 v[96:99], v36 offset:8192
    ds_read_b128 v[100:103], v37 offset:8192
    ds_read_b128 v[104:107], v38 offset:8192
    ds_read_b128 v[108:111], v39 offset:8192
    s_waitcnt lgkmcnt(6)
    ds_read_b128 v[112:115], v36 offset:12288
    ds_read_b128 v[116:119], v37 offset:12288
    ds_read_b128 v[120:123], v38 offset:12288
    ds_read_b128 v[124:127], v39 offset:12288
    v_cmp_ne_u32 vcc, s35, v6
    s_cbranch_vccz LBok_66
    s_mov_b32 s37, 100000
LB_67:
    buffer_load_dwordx4 v[4:7], v40, s[40:43], s69 offen sc1
    s_waitcnt vmcnt(0)
    v_cmp_ne_u32 vcc, s35, v6
    s_cbranch_vccz LBok_66
    s_cmp_lt_u32 s37, 99800
    s_cselect_b32 s39, 2097152, 0
    s_xor_b32 s69, s69, s39
    s_sub_u32 s37, s37, 1
    s_cbranch_scc0 LB_67
LBok_66:
    ds_write_b64 v41, v[4:5]
    s_branch Lkj_65
Lknp_64:
    s_waitcnt vmcnt(0)
    s_getreg_b32 s39, hwreg(HW_REG_XCC_ID, 0, 4)
    s_add_u32 s39, s39, s35
    v_cmp_ne_u32 vcc, s39, v210
    s_nop 0
    s_cmp_eq_u64 vcc, 0
    s_cselect_b32 s90, 1, 0
    ds_read_b128 v[64:67], v36 offset:0
    ds_read_b128 v[68:71], v37 offset:0
    ds_read_b128 v[72:75], v38 offset:0
    ds_read_b128 v[76:79], v39 offset:0
    ds_read_b128 v[80:83], v36 offset:4096
    ds_read_b128 v[84:87], v37 offset:4096
    ds_read_b128 v[88:91], v38 offset:4096
    ds_read_b128 v[92:95], v39 offset:4096
    ds_read_b128 v[96:99], v36 offset:8192
    ds_read_b128 v[100:103], v37 offset:8192
    ds_read_b128 v[104:107], v38 offset:8192
    ds_read_b128 v[108:111], v39 offset:8192
    s_waitcnt lgkmcnt(6)
    ds_read_b128 v[112:115], v36 offset:12288
    ds_read_b128 v[116:119], v37 offset:12288
    ds_read_b128 v[120:123], v38 offset:12288
    ds_read_b128 v[124:127], v39 offset:12288
Lkj_65:
    s_waitcnt lgkmcnt(0)
    s_barrier
    ds_read_b128 v[44:47], v42 offset:0
    ds_read_b128 v[48:51], v42 offset:64
    ds_read_b128 v[52:55], v42 offset:128
    ds_read_b128 v[56:59], v42 offset:192
    s_waitcnt lgkmcnt(3)
    v_mfma_f32_16x16x32_bf16 v[4:7], v[64:67], v[44:47], 0
    v_mfma_f32_16x16x32_bf16 v[8:11], v[80:83], v[44:47], 0
    v_mfma_f32_16x16x32_bf16 v[12:15], v[96:99], v[44:47], 0
    v_mfma_f32_16x16x32_bf16 v[16:19], v[112:115], v[44:47], 0
    s_waitcnt lgkmcnt(2)
    v_mfma_f32_16x16x32_bf16 v[4:7], v[68:71], v[48:51], v[4:7]
    v_mfma_f32_16x16x32_bf16 v[8:11], v[84:87], v[48:51], v[8:11]
    v_mfma_f32_16x16x32_bf16 v[12:15], v[100:103], v[48:51], v[12:15]
    v_mfma_f32_16x16x32_bf16 v[16:19], v[116:119], v[48:51], v[16:19]
    s_waitcnt lgkmcnt(1)
    v_mfma_f32_16x16x32_bf16 v[4:7], v[72:75], v[52:55], v[4:7]
    v_mfma_f32_16x16x32_bf16 v[8:11], v[88:91], v[52:55], v[8:11]
    v_mfma_f32_16x16x32_bf16 v[12:15], v[104:107], v[52:55], v[12:15]
    v_mfma_f32_16x16x32_bf16 v[16:19], v[120:123], v[52:55], v[16:19]
    s_waitcnt lgkmcnt(0)
    v_mfma_f32_16x16x32_bf16 v[4:7], v[76:79], v[56:59], v[4:7]
    v_mfma_f32_16x16x32_bf16 v[8:11], v[92:95], v[56:59], v[8:11]
    v_mfma_f32_16x16x32_bf16 v[12:15], v[108:111], v[56:59], v[12:15]
    v_mfma_f32_16x16x32_bf16 v[16:19], v[124:127], v[56:59], v[16:19]
    s_nop 5
    v_mov_b32_dpp v4, v8 quad_perm:[0,1,2,3] row_mask:0xf bank_mask:0x2
    v_mov_b32_dpp v5, v9 quad_perm:[0,1,2,3] row_mask:0xf bank_mask:0x2
    v_mov_b32_dpp v6, v10 quad_perm:[0,1,2,3] row_mask:0xf bank_mask:0x2
    v_mov_b32_dpp v7, v11 quad_perm:[0,1,2,3] row_mask:0xf bank_mask:0x2
    v_mov_b32_dpp v4, v12 quad_perm:[0,1,2,3] row_mask:0xf bank_mask:0x4
    v_mov_b32_dpp v5, v13 quad_perm:[0,1,2,3] row_mask:0xf bank_mask:0x4
    v_mov_b32_dpp v6, v14 quad_perm:[0,1,2,3] row_mask:0xf bank_mask:0x4
    v_mov_b32_dpp v7, v15 quad_perm:[0,1,2,3] row_mask:0xf bank_mask:0x4
    v_mov_b32_dpp v4, v16 quad_perm:[0,1,2,3] row_mask:0xf bank_mask:0x8
    v_mov_b32_dpp v5, v17 quad_perm:[0,1,2,3] row_mask:0xf bank_mask:0x8
    v_mov_b32_dpp v6, v18 quad_perm:[0,1,2,3] row_mask:0xf bank_mask:0x8
    v_mov_b32_dpp v7, v19 quad_perm:[0,1,2,3] row_mask:0xf bank_mask:0x8
    v_cvt_pk_bf16_f32 v8, v4, v5
    v_cvt_pk_bf16_f32 v9, v6, v7
    v_lshlrev_b32 v4, 16, v8
    v_and_b32 v5, 0xffff0000, v8
    v_lshlrev_b32 v6, 16, v9
    v_and_b32 v7, 0xffff0000, v9
    v_mul_f32 v4, 0x3db504f3, v4
    v_mul_f32 v5, 0x3db504f3, v5
    v_mul_f32 v6, 0x3db504f3, v6
    v_mul_f32 v7, 0x3db504f3, v7
    v_cvt_pk_bf16_f32 v8, v4, v5
    v_cvt_pk_bf16_f32 v9, v6, v7
    v_mov_b32 v10, s35
    v_mov_b32 v11, 0
    s_or_b32 s39, s63, 2097152
    buffer_store_dwordx4 v[8:11], v43, s[40:43], s39 offen
    s_barrier
    s_cmp_eq_u32 s90, 1
    s_cbranch_scc1 Lsg_69
    buffer_store_dwordx4 v[8:11], v43, s[40:43], s63 offen sc0 sc1
Lsg_69:
    s_cmp_lt_u32 s66, 48
    s_cbranch_scc0 Lkend_68
    s_mov_b32 m0, s62
    s_mov_b32 s52, s22
    s_mov_b32 s53, s23
    s_mov_b32 s54, 4096
    s_mov_b32 s55, 0x20000
    s_cmp_lt_u32 s34, 4
    s_cbranch_scc0 Lkc_70
    s_lshl_b32 s61, s34, 10
    s_lshl_b32 s69, s67, 9
    s_add_u32 s69, s69, s61
    v_lshlrev_b32 v7, 3, v0
    buffer_load_dwordx2 v[24:25], v7, s[52:55], s69 offen
Lkc_70:
    s_mov_b32 s38, 4
Ldma_71:
    buffer_load_dwordx4 v32, s[48:51], s59 offen lds
    s_add_u32 s59, s59, 49152
    s_add_u32 m0, m0, 1024
    s_sub_u32 s38, s38, 1
    s_cmp_lg_u32 s38, 0
    s_cbranch_scc1 Ldma_71
    s_cmp_lt_u32 s34, 4
    s_cbranch_scc0 Lks_72
    s_waitcnt vmcnt(4)
    v_lshlrev_b32 v8, 16, v24
    v_and_b32 v9, 0xffff0000, v24
    v_lshlrev_b32 v10, 16, v25
    v_and_b32 v11, 0xffff0000, v25
    s_mov_b32 s94, 0xbfb8aa3b
    s_mov_b32 s95, 0xb2a57060
    v_mul_f32 v12, 0xbfb8aa3b, v8
    v_fma_f32 v16, v8, s94, -v12
    v_fma_f32 v16, v8, s95, v16
    v_exp_f32 v12, v12
    v_mul_f32 v16, 0x3f317218, v16
    v_add_f32 v16, 1.0, v16
    v_mul_f32 v12, v12, v16
    v_add_f32 v12, 1.0, v12
    v_rcp_f32 v16, v12
    v_cmp_eq_f32 vcc, 0x7f800000, v12
    v_mul_f32 v20, v8, v16
    v_fma_f32 v21, -v20, v12, v8
    v_fma_f32 v21, v21, v16, v20
    v_cndmask_b32 v8, v21, v20, vcc
    v_mul_f32 v13, 0xbfb8aa3b, v9
    v_fma_f32 v17, v9, s94, -v13
    v_fma_f32 v17, v9, s95, v17
    v_exp_f32 v13, v13
    v_mul_f32 v17, 0x3f317218, v17
    v_add_f32 v17, 1.0, v17
    v_mul_f32 v13, v13, v17
    v_add_f32 v13, 1.0, v13
    v_rcp_f32 v17, v13
    v_cmp_eq_f32 vcc, 0x7f800000, v13
    v_mul_f32 v20, v9, v17
    v_fma_f32 v21, -v20, v13, v9
    v_fma_f32 v21, v21, v17, v20
    v_cndmask_b32 v9, v21, v20, vcc
    v_mul_f32 v14, 0xbfb8aa3b, v10
    v_fma_f32 v18, v10, s94, -v14
    v_fma_f32 v18, v10, s95, v18
    v_exp_f32 v14, v14
    v_mul_f32 v18, 0x3f317218, v18
    v_add_f32 v18, 1.0, v18
    v_mul_f32 v14, v14, v18
    v_add_f32 v14, 1.0, v14
    v_rcp_f32 v18, v14
    v_cmp_eq_f32 vcc, 0x7f800000, v14
    v_mul_f32 v20, v10, v18
    v_fma_f32 v21, -v20, v14, v10
    v_fma_f32 v21, v21, v18, v20
    v_cndmask_b32 v10, v21, v20, vcc
    v_mul_f32 v15, 0xbfb8aa3b, v11
    v_fma_f32 v19, v11, s94, -v15
    v_fma_f32 v19, v11, s95, v19
    v_exp_f32 v15, v15
    v_mul_f32 v19, 0x3f317218, v19
    v_add_f32 v19, 1.0, v19
    v_mul_f32 v15, v15, v19
    v_add_f32 v15, 1.0, v15
    v_rcp_f32 v19, v15
    v_cmp_eq_f32 vcc, 0x7f800000, v15
    v_mul_f32 v20, v11, v19
    v_fma_f32 v21, -v20, v15, v11
    v_fma_f32 v21, v21, v19, v20
    v_cndmask_b32 v11, v21, v20, vcc
    v_cvt_pk_bf16_f32 v8, v8, v9
    v_cvt_pk_bf16_f32 v9, v10, v11
    v_lshrrev_b32 v5, 3, v0
    v_lshlrev_b32 v5, 6, v5
    v_and_b32 v6, 3, v0
    v_lshl_add_u32 v5, v6, 4, v5
    v_bfe_u32 v6, v0, 2, 1
    v_lshl_add_u32 v5, v6, 3, v5
    s_mul_i32 s61, s34, 544
    s_add_u32 s61, s61, 132224
    v_add_u32 v5, s61, v5
    ds_write_b64 v5, v[8:9]
Lks_72:
    s_lshl_b32 s61, s34, 5
    v_lshrrev_b32 v1, 4, v0
    v_lshlrev_b32 v33, 9, v1
    v_and_b32 v1, 1, v1
    v_lshlrev_b32 v1, 6, v1
    v_bfe_u32 v2, v0, 2, 2
    v_lshl_add_u32 v33, v2, 7, v33
    v_lshrrev_b32 v2, 1, v2
    v_lshl_or_b32 v1, v2, 5, v1
    v_xor_b32 v1, s61, v1
    v_add_u32 v33, v33, v1
    v_and_b32 v2, 3, v0
    v_lshl_add_u32 v33, v2, 3, v33
    v_add_u32 v33, 0, v33
    v_add_u32 v34, 65536, v33
    v_and_b32 v1, 3, v0
    v_mul_u32_u24 v35, 544, v1
    v_lshrrev_b32 v1, 4, v0
    v_lshl_add_u32 v35, v1, 4, v35
    v_add_u32 v35, 132224, v35
    v_lshrrev_b32 v1, 5, v0
    v_lshlrev_b32 v36, 10, v1
    v_and_b32 v1, 3, v0
    v_lshl_add_u32 v36, v1, 5, v36
    v_bfe_u32 v1, v0, 4, 1
    v_lshl_add_u32 v36, v1, 4, v36
    s_lshl_b32 s59, s56, 13
    s_lshl_b32 s61, s34, 11
    s_add_u32 s59, s59, s61
    s_lshl_b32 s61, s68, 8
    s_add_u32 s59, s59, s61
    s_lshl_b32 s61, s67, 7
    s_add_u32 s59, s59, s61
    s_add_u32 s59, s59, 995328
    s_mov_b32 s92, 0x0c0c0400
    s_mov_b32 s93, 0x04000c0c
    s_movk_i32 s91, 0xff
    v_mov_b32 v28, s35
    v_lshrrev_b32 v29, 8, v28
    v_lshrrev_b32 v30, 16, v28
    v_lshrrev_b32 v31, 24, v28
    s_waitcnt vmcnt(0) lgkmcnt(0)
    s_barrier
    s_cmp_lt_u32 s34, 4
    s_cbranch_scc0 Lkend_68
    ds_read_b128 v[96:99], v35 offset:0
    ds_read_b128 v[100:103], v35 offset:64
    ds_read_b128 v[104:107], v35 offset:128
    ds_read_b128 v[108:111], v35 offset:192
    ds_read_b128 v[112:115], v35 offset:256
    ds_read_b128 v[116:119], v35 offset:320
    ds_read_b128 v[120:123], v35 offset:384
    ds_read_b128 v[124:127], v35 offset:448
    s_waitcnt lgkmcnt(2)
    ds_read_b64_tr_b16 v[64:65], v33 offset:0
    ds_read_b64_tr_b16 v[66:67], v33 offset:2048
    ds_read_b64_tr_b16 v[68:69], v33 offset:16384
    ds_read_b64_tr_b16 v[70:71], v33 offset:18432
    ds_read_b64_tr_b16 v[72:73], v33 offset:32768
    ds_read_b64_tr_b16 v[74:75], v33 offset:34816
    ds_read_b64_tr_b16 v[76:77], v33 offset:49152
    ds_read_b64_tr_b16 v[78:79], v33 offset:51200
    ds_read_b64_tr_b16 v[80:81], v34 offset:0
    ds_read_b64_tr_b16 v[82:83], v34 offset:2048
    ds_read_b64_tr_b16 v[84:85], v34 offset:16384
    ds_read_b64_tr_b16 v[86:87], v34 offset:18432
    s_waitcnt lgkmcnt(6)
    ds_read_b64_tr_b16 v[88:89], v34 offset:32768
    ds_read_b64_tr_b16 v[90:91], v34 offset:34816
    ds_read_b64_tr_b16 v[92:93], v34 offset:49152
    ds_read_b64_tr_b16 v[94:95], v34 offset:51200
    s_waitcnt lgkmcnt(8)
    v_mfma_f32_16x16x32_bf16 v[4:7], v[64:67], v[96:99], 0
    s_nop 0
    v_mfma_f32_16x16x32_bf16 v[4:7], v[68:71], v[100:103], v[4:7]
    s_nop 0
    v_mfma_f32_16x16x32_bf16 v[4:7], v[72:75], v[104:107], v[4:7]
    s_nop 0
    v_mfma_f32_16x16x32_bf16 v[4:7], v[76:79], v[108:111], v[4:7]
    s_waitcnt lgkmcnt(6)
    v_mfma_f32_16x16x32_bf16 v[4:7], v[80:83], v[112:115], v[4:7]
    s_waitcnt lgkmcnt(4)
    v_mfma_f32_16x16x32_bf16 v[4:7], v[84:87], v[116:119], v[4:7]
    s_waitcnt lgkmcnt(2)
    v_mfma_f32_16x16x32_bf16 v[4:7], v[88:91], v[120:123], v[4:7]
    s_waitcnt lgkmcnt(0)
    v_mfma_f32_16x16x32_bf16 v[4:7], v[92:95], v[124:127], v[4:7]
    s_nop 7
    v_bfi_b32 v4, s91, v28, v4
    v_bfi_b32 v5, s91, v29, v5
    v_bfi_b32 v6, s91, v30, v6
    v_bfi_b32 v7, s91, v31, v7
    s_mov_b32 exec_lo, 0x000f000f
    s_mov_b32 exec_hi, 0x000f000f
    buffer_store_dwordx4 v[4:7], v36, s[40:43], s59 offen sc0 sc1
    s_mov_b64 exec, -1
Lkend_68:
    s_endpgm
L_ROLE_V:
    s_mov_b32 s40, s30
    s_mov_b32 s41, s31
    s_mov_b32 s42, 4194304
    s_mov_b32 s43, 0x20000
    v_bfe_u32 v1, v0, 2, 2
    v_lshlrev_b32 v33, 9, v1
    v_lshrrev_b32 v2, 4, v0
    v_lshl_add_u32 v33, v2, 6, v33
    v_and_b32 v3, 3, v0
    v_lshl_add_u32 v33, v3, 4, v33
    s_lshl_b32 s63, s60, 14
    s_add_u32 s63, s63, 339968
    s_lshl_b32 s61, s34, 11
    s_add_u32 s63, s63, s61
    v_mul_u32_u24 v38, 272, v3
    v_lshl_add_u32 v38, v1, 6, v38
    v_lshl_add_u32 v38, v2, 4, v38
    s_mul_i32 s61, s34, 1088
    s_add_u32 s61, s61, 131072
    v_add_u32 v38, s61, v38
    v_lshlrev_b32 v39, 6, v3
    v_add_u32 v40, 139776, v39
    s_lshl_b32 s61, s34, 3
    v_add_u32 v39, s61, v40
    v_lshl_add_u32 v40, v1, 3, v40
    v_and_b32 v2, 1, v2
    v_lshl_add_u32 v40, v2, 5, v40
    v_lshrrev_b32 v1, 4, v0
    v_lshlrev_b32 v34, 9, v1
    v_and_b32 v1, 1, v1
    v_lshlrev_b32 v1, 6, v1
    v_bfe_u32 v2, v0, 2, 2
    v_lshl_add_u32 v34, v2, 7, v34
    v_lshrrev_b32 v2, 1, v2
    v_lshl_or_b32 v1, v2, 5, v1
    v_xor_b32 v1, 0, v1
    v_add_u32 v34, v34, v1
    v_and_b32 v2, 3, v0
    v_lshl_add_u32 v34, v2, 3, v34
    v_add_u32 v34, s62, v34
    v_lshrrev_b32 v1, 4, v0
    v_lshlrev_b32 v35, 9, v1
    v_and_b32 v1, 1, v1
    v_lshlrev_b32 v1, 6, v1
    v_bfe_u32 v2, v0, 2, 2
    v_lshl_add_u32 v35, v2, 7, v35
    v_lshrrev_b32 v2, 1, v2
    v_lshl_or_b32 v1, v2, 5, v1
    v_xor_b32 v1, 32, v1
    v_add_u32 v35, v35, v1
    v_and_b32 v2, 3, v0
    v_lshl_add_u32 v35, v2, 3, v35
    v_add_u32 v35, s62, v35
    v_lshrrev_b32 v1, 4, v0
    v_lshlrev_b32 v36, 9, v1
    v_and_b32 v1, 1, v1
    v_lshlrev_b32 v1, 6, v1
    v_bfe_u32 v2, v0, 2, 2
    v_lshl_add_u32 v36, v2, 7, v36
    v_lshrrev_b32 v2, 1, v2
    v_lshl_or_b32 v1, v2, 5, v1
    v_xor_b32 v1, 64, v1
    v_add_u32 v36, v36, v1
    v_and_b32 v2, 3, v0
    v_lshl_add_u32 v36, v2, 3, v36
    v_add_u32 v36, s62, v36
    v_lshrrev_b32 v1, 4, v0
    v_lshlrev_b32 v37, 9, v1
    v_and_b32 v1, 1, v1
    v_lshlrev_b32 v1, 6, v1
    v_bfe_u32 v2, v0, 2, 2
    v_lshl_add_u32 v37, v2, 7, v37
    v_lshrrev_b32 v2, 1, v2
    v_lshl_or_b32 v1, v2, 5, v1
    v_xor_b32 v1, 96, v1
    v_add_u32 v37, v37, v1
    v_and_b32 v2, 3, v0
    v_lshl_add_u32 v37, v2, 3, v37
    v_add_u32 v37, s62, v37
    v_lshrrev_b32 v1, 4, v0
    v_mul_u32_u24 v1, 272, v1
    v_and_b32 v2, 15, v0
    v_lshl_add_u32 v1, v2, 4, v1
    v_add_u32 v41, 131072, v1
    v_lshrrev_b32 v1, 4, v0
    v_lshlrev_b32 v1, 6, v1
    v_add_u32 v43, 139776, v1
    v_lshlrev_b32 v42, 4, v0
    s_lshl_b32 s66, s32, 2
    s_add_u32 s66, s66, s57
    s_lshl_b32 s66, s66, 1
    s_add_u32 s66, s66, s58
    s_lshl_b32 s66, s66, 10
    s_add_u32 s66, s66, 864256
    s_waitcnt lgkmcnt(0)
    s_add_u32 s35, s36, 2654435769
    v_and_b32 v211, 31, v0
    v_lshlrev_b32 v211, 2, v211
    s_lshl_b32 s90, s32, 7
    buffer_load_dword v210, v211, s[40:43], s90 offen offset:2048 sc1
    s_or_b32 s63, s63, 2097152
    buffer_load_dwordx4 v[4:7], v33, s[40:43], s63 offen sc1
    buffer_load_dwordx4 v[8:11], v33, s[40:43], s63 offen offset:256 sc1
    s_waitcnt vmcnt(0)
    s_getreg_b32 s39, hwreg(HW_REG_XCC_ID, 0, 4)
    s_add_u32 s39, s39, s35
    v_cmp_ne_u32 vcc, s39, v210
    s_nop 0
    s_cmp_eq_u64 vcc, 0
    s_cselect_b32 s90, 1, 0
    ds_read_b64_tr_b16 v[64:65], v34 offset:0
    ds_read_b64_tr_b16 v[66:67], v34 offset:2048
    ds_read_b64_tr_b16 v[68:69], v35 offset:0
    ds_read_b64_tr_b16 v[70:71], v35 offset:2048
    ds_read_b64_tr_b16 v[72:73], v36 offset:0
    ds_read_b64_tr_b16 v[74:75], v36 offset:2048
    ds_read_b64_tr_b16 v[76:77], v37 offset:0
    ds_read_b64_tr_b16 v[78:79], v37 offset:2048
    s_waitcnt lgkmcnt(6)
    ds_read_b64_tr_b16 v[80:81], v34 offset:4096
    ds_read_b64_tr_b16 v[82:83], v34 offset:6144
    ds_read_b64_tr_b16 v[84:85], v35 offset:4096
    ds_read_b64_tr_b16 v[86:87], v35 offset:6144
    ds_read_b64_tr_b16 v[88:89], v36 offset:4096
    ds_read_b64_tr_b16 v[90:91], v36 offset:6144
    ds_read_b64_tr_b16 v[92:93], v37 offset:4096
    ds_read_b64_tr_b16 v[94:95], v37 offset:6144
    s_waitcnt lgkmcnt(6)
    ds_read_b64_tr_b16 v[96:97], v34 offset:8192
    ds_read_b64_tr_b16 v[98:99], v34 offset:10240
    ds_read_b64_tr_b16 v[100:101], v35 offset:8192
    ds_read_b64_tr_b16 v[102:103], v35 offset:10240
    ds_read_b64_tr_b16 v[104:105], v36 offset:8192
    ds_read_b64_tr_b16 v[106:107], v36 offset:10240
    ds_read_b64_tr_b16 v[108:109], v37 offset:8192
    ds_read_b64_tr_b16 v[110:111], v37 offset:10240
    s_waitcnt lgkmcnt(6)
    ds_read_b64_tr_b16 v[112:113], v34 offset:12288
    ds_read_b64_tr_b16 v[114:115], v34 offset:14336
    ds_read_b64_tr_b16 v[116:117], v35 offset:12288
    ds_read_b64_tr_b16 v[118:119], v35 offset:14336
    ds_read_b64_tr_b16 v[120:121], v36 offset:12288
    ds_read_b64_tr_b16 v[122:123], v36 offset:14336
    ds_read_b64_tr_b16 v[124:125], v37 offset:12288
    ds_read_b64_tr_b16 v[126:127], v37 offset:14336
    v_cmp_ne_u32 vcc, s35, v6
    v_cmp_ne_u32 s[64:65], s35, v10
    s_nop 0
    s_or_b64 vcc, vcc, s[64:65]
    s_cbranch_scc0 LSok_73
    s_mov_b32 s37, 100000
LS_74:
    buffer_load_dwordx4 v[4:7], v33, s[40:43], s63 offen sc1
    buffer_load_dwordx4 v[8:11], v33, s[40:43], s63 offen offset:256 sc1
    s_waitcnt vmcnt(0)
    v_cmp_ne_u32 vcc, s35, v6
    v_cmp_ne_u32 s[64:65], s35, v10
    s_nop 0
    s_or_b64 vcc, vcc, s[64:65]
    s_cbranch_scc0 LSok_73
    s_cmp_lt_u32 s37, 99800
    s_cselect_b32 s39, 2097152, 0
    s_xor_b32 s63, s63, s39
    s_sub_u32 s37, s37, 1
    s_cbranch_scc0 LS_74
LSok_73:
    v_lshlrev_b32 v12, 16, v4
    v_and_b32 v13, 0xffff0000, v4
    v_lshlrev_b32 v14, 16, v5
    v_and_b32 v15, 0xffff0000, v5
    v_lshlrev_b32 v16, 16, v8
    v_and_b32 v17, 0xffff0000, v8
    v_lshlrev_b32 v18, 16, v9
    v_and_b32 v19, 0xffff0000, v9
    s_mov_b32 s94, 0x3fb8aa3b
    v_max3_f32 v20, v12, v13, v14
    v_max3_f32 v21, v15, v16, v17
    v_max3_f32 v20, v20, v18, v19
    v_max_f32 v20, v20, v21
    s_nop 1
    v_max_f32_dpp v20, v20, v20 row_ror:4 row_mask:0xf bank_mask:0xf
    s_nop 1
    v_max_f32_dpp v20, v20, v20 row_ror:8 row_mask:0xf bank_mask:0xf
    v_mov_b32 v21, v20
    s_nop 1
    v_permlane16_swap_b32 v20, v21
    v_max_f32 v20, v20, v21
    v_mov_b32 v21, v20
    s_nop 1
    v_permlane32_swap_b32 v20, v21
    v_max_f32 v20, v20, v21
    v_mul_f32 v21, s94, v20
    v_fma_f32 v12, v12, s94, -v21
    v_fma_f32 v13, v13, s94, -v21
    v_fma_f32 v14, v14, s94, -v21
    v_fma_f32 v15, v15, s94, -v21
    v_fma_f32 v16, v16, s94, -v21
    v_fma_f32 v17, v17, s94, -v21
    v_fma_f32 v18, v18, s94, -v21
    v_fma_f32 v19, v19, s94, -v21
    v_exp_f32 v12, v12
    v_exp_f32 v13, v13
    v_exp_f32 v14, v14
    v_exp_f32 v15, v15
    v_exp_f32 v16, v16
    v_exp_f32 v17, v17
    v_exp_f32 v18, v18
    v_exp_f32 v19, v19
    v_cvt_pk_bf16_f32 v44, v12, v13
    v_cvt_pk_bf16_f32 v45, v14, v15
    v_cvt_pk_bf16_f32 v46, v16, v17
    v_cvt_pk_bf16_f32 v47, v18, v19
    s_waitcnt lgkmcnt(0)
    v_mov_b32_dpp v52, v44 row_ror:8 row_mask:0xf bank_mask:0xf
    v_mov_b32_dpp v53, v45 row_ror:8 row_mask:0xf bank_mask:0xf
    v_mov_b32_dpp v54, v46 row_ror:8 row_mask:0xf bank_mask:0xf
    v_mov_b32_dpp v55, v47 row_ror:8 row_mask:0xf bank_mask:0xf
    v_mfma_f32_16x16x32_bf16 v[4:7], v[64:67], v[44:47], 0
    v_mfma_f32_16x16x32_bf16 v[8:11], v[84:87], v[44:47], 0
    v_mfma_f32_16x16x32_bf16 v[24:27], v[104:107], v[44:47], 0
    v_mfma_f32_16x16x32_bf16 v[28:31], v[124:127], v[44:47], 0
    v_mov_b32_dpp v48, v44 row_ror:12 row_mask:0xf bank_mask:0xf
    v_mov_b32_dpp v49, v45 row_ror:12 row_mask:0xf bank_mask:0xf
    v_mov_b32_dpp v50, v46 row_ror:12 row_mask:0xf bank_mask:0xf
    v_mov_b32_dpp v51, v47 row_ror:12 row_mask:0xf bank_mask:0xf
    v_mfma_f32_16x16x32_bf16 v[4:7], v[96:99], v[52:55], v[4:7]
    v_mfma_f32_16x16x32_bf16 v[8:11], v[116:119], v[52:55], v[8:11]
    v_mfma_f32_16x16x32_bf16 v[24:27], v[72:75], v[52:55], v[24:27]
    v_mfma_f32_16x16x32_bf16 v[28:31], v[92:95], v[52:55], v[28:31]
    v_mov_b32_dpp v56, v44 row_ror:4 row_mask:0xf bank_mask:0xf
    v_mov_b32_dpp v57, v45 row_ror:4 row_mask:0xf bank_mask:0xf
    v_mov_b32_dpp v58, v46 row_ror:4 row_mask:0xf bank_mask:0xf
    v_mov_b32_dpp v59, v47 row_ror:4 row_mask:0xf bank_mask:0xf
    v_mfma_f32_16x16x32_bf16 v[4:7], v[80:83], v[48:51], v[4:7]
    v_mfma_f32_16x16x32_bf16 v[8:11], v[100:103], v[48:51], v[8:11]
    v_mfma_f32_16x16x32_bf16 v[24:27], v[120:123], v[48:51], v[24:27]
    v_mfma_f32_16x16x32_bf16 v[28:31], v[76:79], v[48:51], v[28:31]
    v_add_f32 v22, v12, v13
    v_add_f32 v23, v14, v15
    v_add_f32 v12, v16, v17
    v_add_f32 v13, v18, v19
    v_mfma_f32_16x16x32_bf16 v[4:7], v[112:115], v[56:59], v[4:7]
    v_add_f32 v22, v22, v23
    v_add_f32 v12, v12, v13
    v_mfma_f32_16x16x32_bf16 v[8:11], v[68:71], v[56:59], v[8:11]
    v_add_f32 v21, v22, v12
    v_mfma_f32_16x16x32_bf16 v[24:27], v[88:91], v[56:59], v[24:27]
    s_nop 0
    v_add_f32_dpp v21, v21, v21 row_ror:4 row_mask:0xf bank_mask:0xf
    v_mfma_f32_16x16x32_bf16 v[28:31], v[108:111], v[56:59], v[28:31]
    s_nop 0
    v_add_f32_dpp v21, v21, v21 row_ror:8 row_mask:0xf bank_mask:0xf
    v_mov_b32 v22, v21
    s_nop 1
    v_permlane16_swap_b32 v21, v22
    v_add_f32 v21, v21, v22
    v_mov_b32 v22, v21
    s_nop 1
    v_permlane32_swap_b32 v21, v22
    v_add_f32 v21, v21, v22
    s_mov_b64 exec, 0xf
    ds_write_b64 v39, v[20:21]
    s_mov_b64 exec, -1
    v_mov_b32_dpp v4, v8 quad_perm:[0,1,2,3] row_mask:0xf bank_mask:0x2
    v_mov_b32_dpp v5, v9 quad_perm:[0,1,2,3] row_mask:0xf bank_mask:0x2
    v_mov_b32_dpp v6, v10 quad_perm:[0,1,2,3] row_mask:0xf bank_mask:0x2
    v_mov_b32_dpp v7, v11 quad_perm:[0,1,2,3] row_mask:0xf bank_mask:0x2
    v_mov_b32_dpp v4, v24 quad_perm:[0,1,2,3] row_mask:0xf bank_mask:0x4
    v_mov_b32_dpp v5, v25 quad_perm:[0,1,2,3] row_mask:0xf bank_mask:0x4
    v_mov_b32_dpp v6, v26 quad_perm:[0,1,2,3] row_mask:0xf bank_mask:0x4
    v_mov_b32_dpp v7, v27 quad_perm:[0,1,2,3] row_mask:0xf bank_mask:0x4
    v_mov_b32_dpp v4, v28 quad_perm:[0,1,2,3] row_mask:0xf bank_mask:0x8
    v_mov_b32_dpp v5, v29 quad_perm:[0,1,2,3] row_mask:0xf bank_mask:0x8
    v_mov_b32_dpp v6, v30 quad_perm:[0,1,2,3] row_mask:0xf bank_mask:0x8
    v_mov_b32_dpp v7, v31 quad_perm:[0,1,2,3] row_mask:0xf bank_mask:0x8
    ds_write_b128 v38, v[4:7]
    s_waitcnt lgkmcnt(0)
    s_barrier
    s_cmp_eq_u32 s34, 0
    s_cbranch_scc0 Lvdone_75
    ds_read_b128 v[44:47], v43 offset:0
    ds_read_b128 v[48:51], v43 offset:16
    ds_read_b128 v[52:55], v43 offset:32
    ds_read_b128 v[56:59], v43 offset:48
    ds_read_b128 v[64:67], v41 offset:0
    ds_read_b128 v[68:71], v41 offset:1088
    ds_read_b128 v[72:75], v41 offset:2176
    ds_read_b128 v[76:79], v41 offset:3264
    ds_read_b128 v[80:83], v41 offset:4352
    ds_read_b128 v[84:87], v41 offset:5440
    ds_read_b128 v[88:91], v41 offset:6528
    ds_read_b128 v[92:95], v41 offset:7616
    v_mov_b32 v6, s35
    v_mov_b32 v7, 0
    s_waitcnt lgkmcnt(8)
    v_max3_f32 v22, v44, v46, v48
    v_max3_f32 v23, v50, v52, v54
    v_max3_f32 v22, v22, v56, v58
    v_max_f32 v22, v22, v23
    v_sub_f32 v44, v44, v22
    v_sub_f32 v46, v46, v22
    v_sub_f32 v48, v48, v22
    v_sub_f32 v50, v50, v22
    v_sub_f32 v52, v52, v22
    v_sub_f32 v54, v54, v22
    v_sub_f32 v56, v56, v22
    v_sub_f32 v58, v58, v22
    v_mul_f32 v44, s94, v44
    v_mul_f32 v46, s94, v46
    v_mul_f32 v48, s94, v48
    v_mul_f32 v50, s94, v50
    v_mul_f32 v52, s94, v52
    v_mul_f32 v54, s94, v54
    v_mul_f32 v56, s94, v56
    v_mul_f32 v58, s94, v58
    v_exp_f32 v44, v44
    v_exp_f32 v46, v46
    v_exp_f32 v48, v48
    v_exp_f32 v50, v50
    v_exp_f32 v52, v52
    v_exp_f32 v54, v54
    v_exp_f32 v56, v56
    v_exp_f32 v58, v58
    v_mul_f32 v23, v44, v45
    v_fmac_f32 v23, v46, v47
    v_fmac_f32 v23, v48, v49
    v_fmac_f32 v23, v50, v51
    v_fmac_f32 v23, v52, v53
    v_fmac_f32 v23, v54, v55
    v_fmac_f32 v23, v56, v57
    v_fmac_f32 v23, v58, v59
    v_mov_b32 v45, v44
    v_mov_b32 v47, v46
    v_mov_b32 v49, v48
    v_mov_b32 v51, v50
    v_mov_b32 v53, v52
    v_mov_b32 v55, v54
    v_mov_b32 v57, v56
    v_mov_b32 v59, v58
    v_rcp_f32 v22, v23
    s_waitcnt lgkmcnt(0)
    v_pk_mul_f32 v[96:97], v[64:65], v[44:45]
    v_pk_mul_f32 v[98:99], v[66:67], v[44:45]
    v_pk_mul_f32 v[100:101], v[68:69], v[46:47]
    v_pk_mul_f32 v[102:103], v[70:71], v[46:47]
    v_pk_fma_f32 v[96:97], v[72:73], v[48:49], v[96:97]
    v_pk_fma_f32 v[98:99], v[74:75], v[48:49], v[98:99]
    v_pk_fma_f32 v[100:101], v[76:77], v[50:51], v[100:101]
    v_pk_fma_f32 v[102:103], v[78:79], v[50:51], v[102:103]
    v_pk_fma_f32 v[96:97], v[80:81], v[52:53], v[96:97]
    v_pk_fma_f32 v[98:99], v[82:83], v[52:53], v[98:99]
    v_pk_fma_f32 v[100:101], v[84:85], v[54:55], v[100:101]
    v_pk_fma_f32 v[102:103], v[86:87], v[54:55], v[102:103]
    v_pk_fma_f32 v[96:97], v[88:89], v[56:57], v[96:97]
    v_pk_fma_f32 v[98:99], v[90:91], v[56:57], v[98:99]
    v_pk_fma_f32 v[100:101], v[92:93], v[58:59], v[100:101]
    v_pk_fma_f32 v[102:103], v[94:95], v[58:59], v[102:103]
    v_mov_b32 v23, v22
    v_pk_add_f32 v[96:97], v[96:97], v[100:101]
    v_pk_add_f32 v[98:99], v[98:99], v[102:103]
    v_pk_mul_f32 v[96:97], v[96:97], v[22:23]
    v_pk_mul_f32 v[98:99], v[98:99], v[22:23]
    v_cvt_pk_bf16_f32 v4, v96, v97
    v_cvt_pk_bf16_f32 v5, v98, v99
    s_or_b32 s39, s66, 2097152
    buffer_store_dwordx4 v[4:7], v42, s[40:43], s39 offen
    s_cmp_eq_u32 s90, 1
    s_cbranch_scc1 Lsg_76
    buffer_store_dwordx4 v[4:7], v42, s[40:43], s66 offen sc0 sc1
Lsg_76:
Lvdone_75:
    s_endpgm
L_END:
    s_endpgm
.section .rodata,"a"
.p2align 6
.amdhsa_kernel adaLN_cond__sliding_block_cached__glu_gated_reglu__decode_kernel
  .amdhsa_next_free_vgpr 216
  .amdhsa_next_free_sgpr 102
  .amdhsa_accum_offset 216
  .amdhsa_group_segment_fixed_size 0
  .amdhsa_kernarg_size 112
  .amdhsa_user_sgpr_count 2
  .amdhsa_user_sgpr_kernarg_segment_ptr 1
  .amdhsa_system_sgpr_workgroup_id_x 1
.end_amdhsa_kernel
```
